```python
import torch

def _softmax(x, axis=-1):
    return torch.softmax(x, dim=axis)
def _gelu(x):
    return torch.nn.functional.gelu(x, approximate="tanh")
def _silu(x):
    return torch.nn.functional.silu(x)
def _sigmoid(x):
    return torch.sigmoid(x)
def _layernorm(x, axis=-1, eps=1e-5):
    m = x.mean(dim=axis, keepdim=True)
    v = x.var(dim=axis, keepdim=True, unbiased=False)
    return (x - m) / torch.sqrt(v + eps)
def _scatter_add(tgt, idx, src, axis=0):
    return tgt.clone().index_add_(axis, idx, src)
def _segment_sum(src, seg, n):
    out = torch.zeros((n,) + src.shape[1:], dtype=src.dtype)
    return out.index_add_(0, seg, src)
def _pad(x, pw):
    flat = tuple(v for pair in reversed(pw) for v in pair)
    return torch.nn.functional.pad(x, flat)

kernel_name = 'recurrent_scan__ssm_conv_h3__glu_gated_swiglu__prompt'

def setup_inputs():

    _w = (lambda a: (lambda t: t.to(torch.bfloat16) if t.is_floating_point() else t)(torch.as_tensor(a)))
    def _A_setup():
        B, S, D = 1, 2048, 512
        ks = 4
        return {
            "q": _w((lambda *s: torch.randn(*s, dtype=torch.bfloat16) * 0.05)(B, S, D)),
            "k": _w((lambda *s: torch.randn(*s, dtype=torch.bfloat16) * 0.8)(B, S, D)),
            "v": _w((lambda *s: torch.randn(*s, dtype=torch.bfloat16) * 0.8)(B, S, D)),
            "shift_k": _w((lambda *s: torch.randn(*s, dtype=torch.bfloat16) * 0.8)(D, ks) * 0.5),
            "ssm_k": _w((lambda *s: torch.randn(*s, dtype=torch.bfloat16) * 0.8)(D, S) * (1.0 / S ** 0.5)),
            "ssm_D": _w((lambda *s: torch.randn(*s, dtype=torch.bfloat16) * 0.8)(D)),
        }
    _A_in = _A_setup()

    def _B_setup():
        B, S, D, F = 1, 2048, 512, 1792
        return {
            "x": _w((lambda *s: torch.randn(*s, dtype=torch.bfloat16) * 0.05)(B, S, D)),
            "w1": _w((lambda *s: torch.randn(*s, dtype=torch.bfloat16) * 0.2)(D, F) * (2.0 / D) ** 0.5),
            "w3": _w((lambda *s: torch.randn(*s, dtype=torch.bfloat16) * 0.2)(D, F) * (2.0 / D) ** 0.5),
            "w2": _w((lambda *s: torch.randn(*s, dtype=torch.bfloat16) * 0.2)(F, D) * (2.0 / F) ** 0.5),
        }
    _B_in = _B_setup()

    return {
        "A_q": _A_in["q"],
        "A_k": _A_in["k"],
        "A_v": _A_in["v"],
        "A_shift_k": _A_in["shift_k"],
        "A_ssm_k": _A_in["ssm_k"],
        "A_ssm_D": _A_in["ssm_D"],
        "B_x": _B_in["x"],
        "B_w1": _B_in["w1"],
        "B_w3": _B_in["w3"],
        "B_w2": _B_in["w2"],
    }

def reference(A_q, A_k, A_v, A_shift_k, A_ssm_k, A_ssm_D, B_x, B_w1, B_w3, B_w2):
    def _A_ref(q, k, v, shift_k, ssm_k, ssm_D):
        B, S, D = q.shape
        ks = shift_k.shape[-1]
        k_pad = _pad(k, ((0, 0), (ks - 1, 0), (0, 0)))
        k_shift = torch.zeros_like(k)
        for t in range(ks):
            k_shift = k_shift + k_pad[:, t:t + S, :] * shift_k[:, ks - 1 - t][None, None, :]
        kv = k_shift * v
        L = 2 * S
        kv_pad = _pad(kv, ((0, 0), (0, S), (0, 0)))
        kf_pad = _pad(ssm_k, ((0, 0), (0, S)))
        kv_f = (lambda x, axes=(-2,-1): torch.fft.rfft2(x.float(), dim=axes))(kv_pad[:, None, :, :], axes=(1, 2))
        kf_f = (lambda x, axes=(-2,-1): torch.fft.rfft2(x.float(), dim=axes))(kf_pad[:, None, :], axes=(1, 2))
        kf_f = (lambda x, *d: x.permute(*d))(kf_f, 1, 2, 0)
        y_f = kv_f * kf_f[None, :, :, :]
        y = (lambda x, s, axes=(-2,-1): torch.fft.irfft2(x, s=s, dim=axes).to(torch.bfloat16))(y_f, (1, L), axes=(1, 2))[:, 0, :S, :]
        y = y + kv * ssm_D[None, None, :]
        return q * y

    def _B_ref(x, w1, w3, w2):
        gate = torch.einsum("bsd,df->bsf", x, w1)
        up = torch.einsum("bsd,df->bsf", x, w3)
        h = _silu(gate) * up
        out = torch.einsum("bsf,fd->bsd", h, w2)
        return out

    x = A_q
    xn = _layernorm(x, axis=-1)
    s = _A_ref(xn, A_k, A_v, A_shift_k, A_ssm_k, A_ssm_D)
    g = _silu(_B_ref(xn, B_w1, B_w3, B_w2))
    return x + s * g
```

```asm
; @launch grid=(256,1,1) block=(512,1,1) lds=163840
.amdgcn_target "amdgcn-amd-amdhsa--gfx950"
.text
.globl recurrent_scan__ssm_conv_h3__glu_gated_swiglu__prompt_kernel
.p2align 8
.type recurrent_scan__ssm_conv_h3__glu_gated_swiglu__prompt_kernel,@function
recurrent_scan__ssm_conv_h3__glu_gated_swiglu__prompt_kernel:
    s_cmp_ge_u32 s2, 256
    s_cbranch_scc1 L_end
    s_getpc_b64 s[88:89]
L_pcref:
    v_cmp_gt_u32 vcc, 64, v0
    s_bfe_u32 s85, s2, 0x20003
    s_mul_i32 s85, s85, 64
    v_add_u32 v2, s85, v0
    v_lshlrev_b32 v2, 7, v2
    v_min_u32 v2, L_code_end-L_pcref-4, v2
    s_and_saveexec_b64 s[96:97], vcc
    s_cbranch_execz L_nopf
    global_load_dword v25, v2, s[88:89]
L_nopf:
    s_mov_b64 exec, -1
    s_load_dwordx2 s[36:37], s[0:1], 0
    s_load_dwordx2 s[48:49], s[0:1], 56
    s_load_dwordx2 s[52:53], s[0:1], 64
    s_load_dwordx2 s[56:57], s[0:1], 8
    s_load_dwordx2 s[60:61], s[0:1], 16
    s_load_dwordx2 s[64:65], s[0:1], 24
    s_load_dwordx2 s[72:73], s[0:1], 88
    v_lshrrev_b32 v2, 6, v0
    v_and_b32 v1, 63, v0
    s_and_b32 s4, s2, 7
    v_readfirstlane_b32 s3, v2
    s_lshr_b32 s5, s2, 3
    s_and_b32 s7, s5, 7
    s_and_b32 s34, s2, 1
    s_lshr_b32 s79, s2, 6
    s_and_b32 s6, s2, 6
    s_lshl_b32 s6, s6, 1
    s_add_u32 s6, s6, s79
    s_mul_i32 s35, s34, 7
    s_add_u32 s35, s35, s7
    s_and_b32 s81, s3, 3
    s_lshl_b32 s91, s81, 10
    s_cmp_lt_u32 s3, 4
    s_cbranch_scc1 L_cstart
    s_mov_b32 s38, 2097152
    s_mov_b32 s39, 0x20000
    s_mov_b32 s50, 1835008
    s_mov_b32 s51, 0x20000
    s_mov_b32 s54, 1835008
    s_mov_b32 s55, 0x20000
    v_lshrrev_b32 v4, 3, v1
    s_lshl_b32 s86, s81, 3
    v_add_u32 v4, s86, v4
    v_lshlrev_b32 v4, 10, v4
    v_lshrrev_b32 v5, 4, v1
    s_and_b32 s86, s81, 1
    s_lshl_b32 s86, s86, 2
    v_add_u32 v6, s86, v5
    v_and_b32 v7, 7, v1
    v_xor_b32 v6, v6, v7
    v_lshl_add_u32 v16, v6, 4, v4
    v_add_u32 v17, 32768, v16
    v_add_u32 v18, 65536, v16
    v_add_u32 v19, 98304, v16
    s_lshl_b32 s86, s81, 2
    v_add_u32 v4, s86, v5
    v_mul_u32_u24 v4, 3584, v4
    v_lshlrev_b32 v6, 1, v5
    s_and_b32 s87, s81, 2
    s_lshl_b32 s87, s87, 2
    v_or_b32 v6, s87, v6
    v_and_b32 v7, 15, v1
    v_xor_b32 v6, v6, v7
    v_lshl_add_u32 v20, v6, 4, v4
    v_add_u32 v21, 57344, v20
    v_add_u32 v22, 114688, v20
    v_add_u32 v23, 172032, v20
    s_lshl_b32 s77, s6, 17
    s_lshl_b32 s78, s35, 8
    s_and_b32 s95, s4, 6
    s_lshl_b32 s85, s34, 2
    s_add_u32 s95, s95, s85
    s_add_u32 s76, s6, s7
    s_and_b32 s76, s76, 1
    s_mov_b32 s58, 2097152
    s_mov_b32 s59, 0x20000
    s_mov_b32 s62, 2097152
    s_mov_b32 s63, 0x20000
    s_mov_b32 s66, 4096
    s_mov_b32 s67, 0x20000
    s_cmp_eq_u32 s7, 7
    s_cbranch_scc1 L_lspare
    s_xor_b32 s92, s76, 0
    s_add_u32 s92, s95, s92
    s_and_b32 s92, s92, 7
    s_mul_i32 s93, s92, 229376
    s_lshl_b32 s92, s92, 7
    s_add_u32 s92, s92, s77
    s_add_u32 s93, s93, s78
    s_waitcnt lgkmcnt(0)
    s_add_u32 m0, s91, 0
    s_nop 0
    buffer_load_dwordx4 v16, s[36:39], s92 offen  lds
    s_add_u32 m0, s91, 16384
    s_nop 0
    buffer_load_dwordx4 v20, s[48:51], s93 offen  lds
    s_add_u32 m0, s91, 32768
    s_nop 0
    buffer_load_dwordx4 v20, s[52:55], s93 offen  lds
    s_add_u32 m0, s91, 4096
    s_nop 0
    buffer_load_dwordx4 v17, s[36:39], s92 offen  lds
    s_add_u32 m0, s91, 20480
    s_nop 0
    buffer_load_dwordx4 v21, s[48:51], s93 offen  lds
    s_add_u32 m0, s91, 36864
    s_nop 0
    buffer_load_dwordx4 v21, s[52:55], s93 offen  lds
    s_add_u32 m0, s91, 8192
    s_nop 0
    buffer_load_dwordx4 v18, s[36:39], s92 offen  lds
    s_add_u32 m0, s91, 12288
    s_nop 0
    buffer_load_dwordx4 v19, s[36:39], s92 offen  lds
    s_add_u32 m0, s91, 24576
    s_nop 0
    buffer_load_dwordx4 v22, s[48:51], s93 offen  lds
    s_add_u32 m0, s91, 40960
    s_nop 0
    buffer_load_dwordx4 v22, s[52:55], s93 offen  lds
    s_add_u32 m0, s91, 28672
    s_nop 0
    buffer_load_dwordx4 v23, s[48:51], s93 offen  lds
    s_add_u32 m0, s91, 45056
    s_nop 0
    buffer_load_dwordx4 v23, s[52:55], s93 offen  lds
    v_lshrrev_b32 v4, 3, v1
    s_lshl_b32 s85, s5, 6
    s_lshl_b32 s86, s81, 4
    s_add_u32 s85, s85, s86
    v_and_b32 v5, 7, v1
    v_lshlrev_b32 v5, 4, v5
    s_lshl_b32 s86, s4, 7
    v_add_u32 v5, s86, v5
    s_sub_u32 s85, s85, 3
    v_lshl_add_u32 v4, v4, 1, s85
    v_lshl_add_u32 v4, v4, 10, v5
    buffer_load_dwordx4 v[48:51], v4, s[56:59], 0 offen
    v_add_u32 v4, 1024, v4
    buffer_load_dwordx4 v[52:55], v4, s[56:59], 0 offen
    v_add_u32 v4, 1024, v4
    buffer_load_dwordx4 v[56:59], v4, s[56:59], 0 offen
    v_add_u32 v4, 1024, v4
    buffer_load_dwordx4 v[60:63], v4, s[56:59], 0 offen
    buffer_load_dwordx4 v[68:71], v4, s[60:63], 0 offen
    v_add_u32 v4, 1024, v4
    buffer_load_dwordx4 v[64:67], v4, s[56:59], 0 offen
    buffer_load_dwordx4 v[72:75], v4, s[60:63], 0 offen
    s_mov_b32 m0, 159872
    v_lshlrev_b32 v4, 4, v1
    s_lshl_b32 s85, s4, 9
    s_mov_b32 exec_hi, 0
    buffer_load_dwordx4 v4, s[64:67], s85 offen lds
    s_mov_b32 exec_hi, -1
    s_load_dwordx2 s[40:41], s[0:1], 96
    s_load_dwordx2 s[68:69], s[0:1], 32
    s_load_dwordx2 s[96:97], s[0:1], 40
    s_load_dwordx2 s[28:29], s[0:1], 72
    s_load_dwordx2 s[44:45], s[0:1], 80
    s_mov_b32 s42, 16777216
    s_mov_b32 s43, 0x20000
    s_mov_b32 s70, 4096
    s_mov_b32 s71, 0x20000
    s_mov_b32 s30, 1835008
    s_mov_b32 s31, 0x20000
    s_mov_b32 s46, 2097152
    s_mov_b32 s47, 0x20000
    s_mov_b32 s74, 256
    s_mov_b32 s75, 0x20000
    s_lshl_b32 s80, s6, 1
    s_add_u32 s80, s80, s34
    s_lshl_b32 s87, s79, 1
    s_add_u32 s32, s7, s87
    s_add_u32 s32, s32, s4
    s_cmp_ge_u32 s32, 7
    s_cselect_b32 s87, 7, 0
    s_sub_u32 s32, s32, s87
    s_cmp_ge_u32 s32, 7
    s_cselect_b32 s87, 7, 0
    s_sub_u32 s32, s32, s87
    v_lshrrev_b32 v4, 3, v1
    v_bfe_u32 v5, v1, 4, 2
    v_lshlrev_b32 v5, 1, v5
    v_and_b32 v6, 7, v1
    v_xor_b32 v5, v5, v6
    v_lshlrev_b32 v4, 10, v4
    v_lshl_add_u32 v15, v5, 4, v4
    s_mul_i32 s85, s81, 458752
    s_lshl_b32 s86, s7, 7
    s_add_u32 s85, s85, s86
    v_add_u32 v15, s85, v15
    s_mul_i32 s90, s81, 12288
    s_lshl_b32 s87, s81, 2
    s_add_u32 s87, s87, 163024
    v_mov_b32 v27, s87
    s_lshl_b32 s94, s4, 5
    s_add_u32 s94, s94, s5
    s_lshl_b32 s87, s94, 2
    s_lshl_b32 s94, s94, 1
    s_lshl_b32 s88, s94, 12
    s_waitcnt lgkmcnt(0)
    s_load_dword s84, s[96:97], s87
    s_add_u32 s68, s68, s88
    s_addc_u32 s69, s69, 0
    s_waitcnt vmcnt(12)
    s_barrier
    s_waitcnt vmcnt(8)
    s_barrier
    s_xor_b32 s92, s76, 1
    s_add_u32 s92, s95, s92
    s_and_b32 s92, s92, 7
    s_mul_i32 s93, s92, 229376
    s_lshl_b32 s92, s92, 7
    s_add_u32 s92, s92, s77
    s_add_u32 s93, s93, s78
    s_add_u32 m0, s91, 49152
    s_nop 0
    buffer_load_dwordx4 v16, s[36:39], s92 offen  lds
    s_add_u32 m0, s91, 65536
    s_nop 0
    buffer_load_dwordx4 v20, s[48:51], s93 offen  lds
    s_add_u32 m0, s91, 81920
    s_nop 0
    buffer_load_dwordx4 v20, s[52:55], s93 offen  lds
    s_add_u32 m0, s91, 53248
    s_nop 0
    buffer_load_dwordx4 v17, s[36:39], s92 offen  lds
    s_add_u32 m0, s91, 69632
    s_nop 0
    buffer_load_dwordx4 v21, s[48:51], s93 offen  lds
    s_add_u32 m0, s91, 86016
    s_nop 0
    buffer_load_dwordx4 v21, s[52:55], s93 offen  lds
    s_add_u32 m0, s91, 57344
    s_nop 0
    buffer_load_dwordx4 v18, s[36:39], s92 offen  lds
    s_add_u32 m0, s91, 61440
    s_nop 0
    buffer_load_dwordx4 v19, s[36:39], s92 offen  lds
    s_add_u32 m0, s91, 73728
    s_nop 0
    buffer_load_dwordx4 v22, s[48:51], s93 offen  lds
    s_add_u32 m0, s91, 90112
    s_nop 0
    buffer_load_dwordx4 v22, s[52:55], s93 offen  lds
    s_add_u32 m0, s91, 77824
    s_nop 0
    buffer_load_dwordx4 v23, s[48:51], s93 offen  lds
    s_add_u32 m0, s91, 94208
    s_nop 0
    buffer_load_dwordx4 v23, s[52:55], s93 offen  lds
    s_waitcnt vmcnt(12)
    s_xor_b32 s92, s76, 2
    s_add_u32 s92, s95, s92
    s_and_b32 s92, s92, 7
    s_mul_i32 s93, s92, 229376
    s_lshl_b32 s92, s92, 7
    s_add_u32 s92, s92, s77
    s_add_u32 s93, s93, s78
    s_add_u32 m0, s91, 98304
    s_nop 0
    buffer_load_dwordx4 v16, s[36:39], s92 offen  lds
    v_and_b32 v5, 7, v1
    v_lshlrev_b32 v4, 6, v5
    v_add_u32 v6, 159872, v4
    ds_read_b128 v[76:79], v6 offset:0
    ds_read_b128 v[80:83], v6 offset:16
    ds_read_b128 v[84:87], v6 offset:32
    ds_read_b128 v[88:91], v6 offset:48
    v_mul_u32_u24 v26, 1040, v5
    v_lshrrev_b32 v4, 3, v1
    s_add_u32 m0, s91, 114688
    s_nop 0
    buffer_load_dwordx4 v20, s[48:51], s93 offen  lds
    s_lshl_b32 s85, s81, 5
    s_sub_u32 s85, 147580, s85
    v_lshlrev_b32 v4, 2, v4
    v_sub_u32 v26, v26, v4
    v_add_u32 v26, s85, v26
    s_waitcnt lgkmcnt(0)
    v_lshlrev_b32 v92, 16, v76
    v_and_b32 v100, 0xffff0000, v76
    v_lshlrev_b32 v108, 16, v77
    s_add_u32 m0, s91, 131072
    s_nop 0
    buffer_load_dwordx4 v20, s[52:55], s93 offen  lds
    v_and_b32 v116, 0xffff0000, v77
    v_lshlrev_b32 v93, 16, v78
    v_and_b32 v101, 0xffff0000, v78
    v_lshlrev_b32 v109, 16, v79
    v_and_b32 v117, 0xffff0000, v79
    v_lshlrev_b32 v94, 16, v80
    v_and_b32 v102, 0xffff0000, v80
    v_lshlrev_b32 v110, 16, v81
    v_and_b32 v118, 0xffff0000, v81
    s_add_u32 m0, s91, 102400
    s_nop 0
    buffer_load_dwordx4 v17, s[36:39], s92 offen  lds
    v_lshlrev_b32 v95, 16, v82
    v_and_b32 v103, 0xffff0000, v82
    v_lshlrev_b32 v111, 16, v83
    v_and_b32 v119, 0xffff0000, v83
    v_lshlrev_b32 v96, 16, v84
    v_and_b32 v104, 0xffff0000, v84
    v_lshlrev_b32 v112, 16, v85
    v_and_b32 v120, 0xffff0000, v85
    v_lshlrev_b32 v97, 16, v86
    s_add_u32 m0, s91, 118784
    s_nop 0
    buffer_load_dwordx4 v21, s[48:51], s93 offen  lds
    v_and_b32 v105, 0xffff0000, v86
    v_lshlrev_b32 v113, 16, v87
    v_and_b32 v121, 0xffff0000, v87
    v_lshlrev_b32 v98, 16, v88
    v_and_b32 v106, 0xffff0000, v88
    v_lshlrev_b32 v114, 16, v89
    v_and_b32 v122, 0xffff0000, v89
    v_lshlrev_b32 v99, 16, v90
    v_and_b32 v107, 0xffff0000, v90
    s_add_u32 m0, s91, 135168
    s_nop 0
    buffer_load_dwordx4 v21, s[52:55], s93 offen  lds
    v_lshlrev_b32 v115, 16, v91
    v_and_b32 v123, 0xffff0000, v91
    v_lshlrev_b32 v124, 16, v48
    v_and_b32 v125, 0xffff0000, v48
    v_lshlrev_b32 v126, 16, v49
    v_and_b32 v127, 0xffff0000, v49
    v_lshlrev_b32 v128, 16, v50
    v_and_b32 v129, 0xffff0000, v50
    v_lshlrev_b32 v130, 16, v51
    s_add_u32 m0, s91, 106496
    s_nop 0
    buffer_load_dwordx4 v18, s[36:39], s92 offen  lds
    v_and_b32 v131, 0xffff0000, v51
    v_mul_f32 v132, v124, v116
    v_mul_f32 v133, v125, v117
    v_mul_f32 v134, v126, v118
    v_mul_f32 v135, v127, v119
    v_mul_f32 v136, v128, v120
    v_mul_f32 v137, v129, v121
    v_mul_f32 v138, v130, v122
    v_mul_f32 v139, v131, v123
    s_add_u32 m0, s91, 110592
    s_nop 0
    buffer_load_dwordx4 v19, s[36:39], s92 offen  lds
    v_lshlrev_b32 v124, 16, v52
    v_and_b32 v125, 0xffff0000, v52
    v_lshlrev_b32 v126, 16, v53
    v_and_b32 v127, 0xffff0000, v53
    v_lshlrev_b32 v128, 16, v54
    v_and_b32 v129, 0xffff0000, v54
    v_lshlrev_b32 v130, 16, v55
    v_and_b32 v131, 0xffff0000, v55
    v_fmac_f32 v132, v124, v108
    s_add_u32 m0, s91, 122880
    s_nop 0
    buffer_load_dwordx4 v22, s[48:51], s93 offen  lds
    v_fmac_f32 v133, v125, v109
    v_fmac_f32 v134, v126, v110
    v_fmac_f32 v135, v127, v111
    v_fmac_f32 v136, v128, v112
    v_fmac_f32 v137, v129, v113
    v_fmac_f32 v138, v130, v114
    v_fmac_f32 v139, v131, v115
    v_mul_f32 v140, v124, v116
    v_mul_f32 v141, v125, v117
    s_add_u32 m0, s91, 139264
    s_nop 0
    buffer_load_dwordx4 v22, s[52:55], s93 offen  lds
    v_mul_f32 v142, v126, v118
    v_mul_f32 v143, v127, v119
    v_mul_f32 v144, v128, v120
    v_mul_f32 v145, v129, v121
    v_mul_f32 v146, v130, v122
    v_mul_f32 v147, v131, v123
    v_lshlrev_b32 v124, 16, v56
    v_and_b32 v125, 0xffff0000, v56
    v_lshlrev_b32 v126, 16, v57
    s_add_u32 m0, s91, 126976
    s_nop 0
    buffer_load_dwordx4 v23, s[48:51], s93 offen  lds
    v_and_b32 v127, 0xffff0000, v57
    v_lshlrev_b32 v128, 16, v58
    v_and_b32 v129, 0xffff0000, v58
    v_lshlrev_b32 v130, 16, v59
    v_and_b32 v131, 0xffff0000, v59
    v_fmac_f32 v132, v124, v100
    v_fmac_f32 v133, v125, v101
    v_fmac_f32 v134, v126, v102
    v_fmac_f32 v135, v127, v103
    s_add_u32 m0, s91, 143360
    s_nop 0
    buffer_load_dwordx4 v23, s[52:55], s93 offen  lds
    s_waitcnt vmcnt(12)
    s_barrier
    s_bfe_u32 s85, s6, 0x10001
    s_xor_b32 s85, s85, s76
    s_and_b32 s86, s6, 1
    s_mul_i32 s85, s85, 49152
    s_lshl_b32 s86, s86, 13
    s_add_u32 s85, s85, s86
    s_add_u32 s85, s85, s91
    v_lshrrev_b32 v5, 4, v1
    v_lshlrev_b32 v6, 1, v5
    s_and_b32 s87, s81, 2
    s_lshl_b32 s87, s87, 2
    v_or_b32 v6, s87, v6
    v_and_b32 v7, 15, v1
    v_xor_b32 v6, v6, v7
    v_lshlrev_b32 v6, 4, v6
    v_lshl_add_u32 v6, v5, 8, v6
    v_add_u32 v6, s85, v6
    ds_read_b128 v[28:31], v6 offset:16384
    ds_read_b128 v[32:35], v6 offset:20480
    ds_read_b128 v[36:39], v6 offset:32768
    ds_read_b128 v[40:43], v6 offset:36864
    s_waitcnt lgkmcnt(0)
    s_xor_b32 s92, s76, 3
    s_add_u32 s92, s95, s92
    s_and_b32 s92, s92, 7
    s_mul_i32 s93, s92, 229376
    s_lshl_b32 s92, s92, 7
    s_add_u32 s92, s92, s77
    s_add_u32 s93, s93, s78
    s_add_u32 m0, s91, 0
    s_nop 0
    buffer_load_dwordx4 v16, s[36:39], s92 offen  lds
    v_and_b32 v7, 15, v1
    v_bfe_u32 v8, v1, 4, 1
    v_lshlrev_b32 v8, 4, v8
    v_lshl_add_u32 v8, v7, 5, v8
    v_lshrrev_b32 v5, 5, v1
    v_lshl_add_u32 v8, v5, 9, v8
    s_add_u32 s85, s91, 155776
    s_add_u32 m0, s91, 16384
    s_nop 0
    buffer_load_dwordx4 v20, s[48:51], s93 offen  lds
    v_add_u32 v8, s85, v8
    v_lshlrev_b32 v208, 16, v28
    v_and_b32 v209, 0xffff0000, v28
    v_lshlrev_b32 v224, 16, v32
    v_and_b32 v225, 0xffff0000, v32
    v_lshlrev_b32 v210, 16, v29
    v_and_b32 v211, 0xffff0000, v29
    s_add_u32 m0, s91, 32768
    s_nop 0
    buffer_load_dwordx4 v20, s[52:55], s93 offen  lds
    v_lshlrev_b32 v226, 16, v33
    v_and_b32 v227, 0xffff0000, v33
    v_lshlrev_b32 v212, 16, v30
    v_and_b32 v213, 0xffff0000, v30
    v_lshlrev_b32 v228, 16, v34
    v_and_b32 v229, 0xffff0000, v34
    v_lshlrev_b32 v214, 16, v31
    s_add_u32 m0, s91, 4096
    s_nop 0
    buffer_load_dwordx4 v17, s[36:39], s92 offen  lds
    v_and_b32 v215, 0xffff0000, v31
    v_lshlrev_b32 v230, 16, v35
    v_and_b32 v231, 0xffff0000, v35
    v_add_f32 v208, v208, v224
    v_add_f32 v209, v209, v225
    v_add_f32 v210, v210, v226
    v_add_f32 v211, v211, v227
    s_add_u32 m0, s91, 20480
    s_nop 0
    buffer_load_dwordx4 v21, s[48:51], s93 offen  lds
    v_add_f32 v212, v212, v228
    v_add_f32 v213, v213, v229
    v_add_f32 v214, v214, v230
    v_add_f32 v215, v215, v231
    v_lshlrev_b32 v216, 16, v36
    v_and_b32 v217, 0xffff0000, v36
    v_lshlrev_b32 v224, 16, v40
    s_add_u32 m0, s91, 36864
    s_nop 0
    buffer_load_dwordx4 v21, s[52:55], s93 offen  lds
    v_and_b32 v225, 0xffff0000, v40
    v_lshlrev_b32 v218, 16, v37
    v_and_b32 v219, 0xffff0000, v37
    v_lshlrev_b32 v226, 16, v41
    v_and_b32 v227, 0xffff0000, v41
    v_lshlrev_b32 v220, 16, v38
    v_and_b32 v221, 0xffff0000, v38
    s_add_u32 m0, s91, 8192
    s_nop 0
    buffer_load_dwordx4 v18, s[36:39], s92 offen  lds
    v_lshlrev_b32 v228, 16, v42
    v_and_b32 v229, 0xffff0000, v42
    v_lshlrev_b32 v222, 16, v39
    v_and_b32 v223, 0xffff0000, v39
    v_lshlrev_b32 v230, 16, v43
    v_and_b32 v231, 0xffff0000, v43
    v_add_f32 v216, v216, v224
    s_add_u32 m0, s91, 12288
    s_nop 0
    buffer_load_dwordx4 v19, s[36:39], s92 offen  lds
    v_add_f32 v217, v217, v225
    v_add_f32 v218, v218, v226
    v_add_f32 v219, v219, v227
    v_add_f32 v220, v220, v228
    v_add_f32 v221, v221, v229
    v_add_f32 v222, v222, v230
    v_add_f32 v223, v223, v231
    s_add_u32 m0, s91, 24576
    s_nop 0
    buffer_load_dwordx4 v22, s[48:51], s93 offen  lds
    s_nop 0
    v_permlane32_swap_b32 v208, v216
    v_permlane32_swap_b32 v209, v217
    v_permlane32_swap_b32 v210, v218
    v_permlane32_swap_b32 v211, v219
    v_permlane32_swap_b32 v212, v220
    v_permlane32_swap_b32 v213, v221
    s_add_u32 m0, s91, 40960
    s_nop 0
    buffer_load_dwordx4 v22, s[52:55], s93 offen  lds
    v_permlane32_swap_b32 v214, v222
    v_permlane32_swap_b32 v215, v223
    v_add_f32 v208, v208, v216
    v_add_f32 v209, v209, v217
    v_add_f32 v210, v210, v218
    v_add_f32 v211, v211, v219
    v_add_f32 v212, v212, v220
    s_add_u32 m0, s91, 28672
    s_nop 0
    buffer_load_dwordx4 v23, s[48:51], s93 offen  lds
    v_add_f32 v213, v213, v221
    v_add_f32 v214, v214, v222
    v_add_f32 v215, v215, v223
    s_nop 0
    v_permlane16_swap_b32 v208, v212
    v_permlane16_swap_b32 v209, v213
    v_permlane16_swap_b32 v210, v214
    s_add_u32 m0, s91, 45056
    s_nop 0
    buffer_load_dwordx4 v23, s[52:55], s93 offen  lds
    v_permlane16_swap_b32 v211, v215
    v_add_f32 v208, v208, v212
    v_add_f32 v209, v209, v213
    v_add_f32 v210, v210, v214
    v_add_f32 v211, v211, v215
    ds_write_b128 v8, v[208:211]
    buffer_load_dwordx2 v[192:193], off, s[72:75], 0 sc1
    s_waitcnt vmcnt(13) lgkmcnt(0)
    s_barrier
    s_lshl_b32 s85, s81, 8
    s_add_u32 s85, s85, 155776
    v_lshlrev_b32 v195, 2, v1
    v_add_u32 v4, s85, v195
    ds_read_b32 v208, v4 offset:0
    ds_read_b32 v209, v4 offset:1024
    ds_read_b32 v210, v4 offset:2048
    ds_read_b32 v211, v4 offset:3072
    s_lshl_b32 s87, s34, 3
    s_add_u32 s87, s87, s7
    s_lshl_b32 s87, s87, 2
    s_add_u32 s87, s87, s81
    s_lshl_b32 s87, s87, 4
    s_add_u32 s87, s87, s6
    s_lshl_b32 s88, s87, 8
    s_add_u32 s88, s88, 12582912
    s_lshl_b32 s89, s87, 3
    s_add_u32 s89, s89, 12877824
    s_waitcnt lgkmcnt(0)
    v_add_f32 v208, v208, v209
    v_add_f32 v210, v210, v211
    v_add_f32 v208, v208, v210
    buffer_store_dword v208, v195, s[40:43], s88 offen sc1
    s_xor_b32 s92, s76, 4
    s_add_u32 s92, s95, s92
    s_and_b32 s92, s92, 7
    s_mul_i32 s93, s92, 229376
    s_lshl_b32 s92, s92, 7
    s_add_u32 s92, s92, s77
    s_add_u32 s93, s93, s78
    s_add_u32 m0, s91, 49152
    s_nop 0
    buffer_load_dwordx4 v16, s[36:39], s92 offen  lds
    v_fmac_f32 v136, v128, v104
    v_fmac_f32 v137, v129, v105
    v_fmac_f32 v138, v130, v106
    v_fmac_f32 v139, v131, v107
    v_fmac_f32 v140, v124, v108
    v_fmac_f32 v141, v125, v109
    v_fmac_f32 v142, v126, v110
    v_fmac_f32 v143, v127, v111
    v_fmac_f32 v144, v128, v112
    s_add_u32 m0, s91, 65536
    s_nop 0
    buffer_load_dwordx4 v20, s[48:51], s93 offen  lds
    v_fmac_f32 v145, v129, v113
    v_fmac_f32 v146, v130, v114
    v_fmac_f32 v147, v131, v115
    v_lshlrev_b32 v124, 16, v60
    v_and_b32 v125, 0xffff0000, v60
    v_lshlrev_b32 v126, 16, v61
    v_and_b32 v127, 0xffff0000, v61
    v_lshlrev_b32 v128, 16, v62
    v_and_b32 v129, 0xffff0000, v62
    s_add_u32 m0, s91, 81920
    s_nop 0
    buffer_load_dwordx4 v20, s[52:55], s93 offen  lds
    v_lshlrev_b32 v130, 16, v63
    v_and_b32 v131, 0xffff0000, v63
    v_fmac_f32 v132, v124, v92
    v_fmac_f32 v133, v125, v93
    v_fmac_f32 v134, v126, v94
    v_fmac_f32 v135, v127, v95
    v_fmac_f32 v136, v128, v96
    v_fmac_f32 v137, v129, v97
    v_fmac_f32 v138, v130, v98
    s_add_u32 m0, s91, 53248
    s_nop 0
    buffer_load_dwordx4 v17, s[36:39], s92 offen  lds
    v_fmac_f32 v139, v131, v99
    v_fmac_f32 v140, v124, v100
    v_fmac_f32 v141, v125, v101
    v_fmac_f32 v142, v126, v102
    v_fmac_f32 v143, v127, v103
    v_fmac_f32 v144, v128, v104
    v_fmac_f32 v145, v129, v105
    v_fmac_f32 v146, v130, v106
    v_fmac_f32 v147, v131, v107
    s_add_u32 m0, s91, 69632
    s_nop 0
    buffer_load_dwordx4 v21, s[48:51], s93 offen  lds
    v_lshlrev_b32 v124, 16, v64
    v_and_b32 v125, 0xffff0000, v64
    v_lshlrev_b32 v126, 16, v65
    v_and_b32 v127, 0xffff0000, v65
    v_lshlrev_b32 v128, 16, v66
    v_and_b32 v129, 0xffff0000, v66
    v_lshlrev_b32 v130, 16, v67
    v_and_b32 v131, 0xffff0000, v67
    v_fmac_f32 v140, v124, v92
    s_add_u32 m0, s91, 86016
    s_nop 0
    buffer_load_dwordx4 v21, s[52:55], s93 offen  lds
    v_fmac_f32 v141, v125, v93
    v_fmac_f32 v142, v126, v94
    v_fmac_f32 v143, v127, v95
    v_fmac_f32 v144, v128, v96
    v_fmac_f32 v145, v129, v97
    v_fmac_f32 v146, v130, v98
    v_fmac_f32 v147, v131, v99
    v_lshlrev_b32 v124, 16, v68
    v_and_b32 v125, 0xffff0000, v68
    s_add_u32 m0, s91, 57344
    s_nop 0
    buffer_load_dwordx4 v18, s[36:39], s92 offen  lds
    v_lshlrev_b32 v126, 16, v69
    v_and_b32 v127, 0xffff0000, v69
    v_lshlrev_b32 v128, 16, v70
    v_and_b32 v129, 0xffff0000, v70
    v_lshlrev_b32 v130, 16, v71
    v_and_b32 v131, 0xffff0000, v71
    v_mul_f32 v132, v132, v124
    v_mul_f32 v133, v133, v125
    v_mul_f32 v134, v134, v126
    s_add_u32 m0, s91, 61440
    s_nop 0
    buffer_load_dwordx4 v19, s[36:39], s92 offen  lds
    v_mul_f32 v135, v135, v127
    v_mul_f32 v136, v136, v128
    v_mul_f32 v137, v137, v129
    v_mul_f32 v138, v138, v130
    v_mul_f32 v139, v139, v131
    v_lshlrev_b32 v124, 16, v72
    v_and_b32 v125, 0xffff0000, v72
    v_lshlrev_b32 v126, 16, v73
    v_and_b32 v127, 0xffff0000, v73
    s_add_u32 m0, s91, 73728
    s_nop 0
    buffer_load_dwordx4 v22, s[48:51], s93 offen  lds
    v_lshlrev_b32 v128, 16, v74
    v_and_b32 v129, 0xffff0000, v74
    v_lshlrev_b32 v130, 16, v75
    v_and_b32 v131, 0xffff0000, v75
    v_mul_f32 v140, v140, v124
    v_mul_f32 v141, v141, v125
    v_mul_f32 v142, v142, v126
    v_mul_f32 v143, v143, v127
    v_mul_f32 v144, v144, v128
    s_add_u32 m0, s91, 90112
    s_nop 0
    buffer_load_dwordx4 v22, s[52:55], s93 offen  lds
    v_mul_f32 v145, v145, v129
    v_mul_f32 v146, v146, v130
    v_mul_f32 v147, v147, v131
    v_cvt_pk_bf16_f32 v124, v140, v132
    v_cvt_pk_bf16_f32 v125, v141, v133
    v_cvt_pk_bf16_f32 v126, v142, v134
    v_cvt_pk_bf16_f32 v127, v143, v135
    v_cvt_pk_bf16_f32 v128, v144, v136
    v_cvt_pk_bf16_f32 v129, v145, v137
    s_add_u32 m0, s91, 77824
    s_nop 0
    buffer_load_dwordx4 v23, s[48:51], s93 offen  lds
    v_cvt_pk_bf16_f32 v130, v146, v138
    v_cvt_pk_bf16_f32 v131, v147, v139
    ds_write_b32 v26, v124 offset:0
    ds_write_b32 v26, v125 offset:128
    ds_write_b32 v26, v126 offset:256
    ds_write_b32 v26, v127 offset:384
    ds_write_b32 v26, v128 offset:512
    ds_write_b32 v26, v129 offset:640
    ds_write_b32 v26, v130 offset:768
    s_add_u32 m0, s91, 94208
    s_nop 0
    buffer_load_dwordx4 v23, s[52:55], s93 offen  lds
    ds_write_b32 v26, v131 offset:896
    s_waitcnt vmcnt(14) lgkmcnt(0)
    s_barrier
    s_xor_b32 s92, s76, 5
    s_add_u32 s92, s95, s92
    s_and_b32 s92, s92, 7
    s_mul_i32 s93, s92, 229376
    s_lshl_b32 s92, s92, 7
    s_add_u32 s92, s92, s77
    s_add_u32 s93, s93, s78
    s_add_u32 m0, s91, 98304
    s_nop 0
    buffer_load_dwordx4 v16, s[36:39], s92 offen  lds
    s_add_u32 m0, s91, 114688
    s_nop 0
    buffer_load_dwordx4 v20, s[48:51], s93 offen  lds
    s_add_u32 m0, s91, 131072
    s_nop 0
    buffer_load_dwordx4 v20, s[52:55], s93 offen  lds
    s_add_u32 m0, s91, 102400
    s_nop 0
    buffer_load_dwordx4 v17, s[36:39], s92 offen  lds
    s_add_u32 m0, s91, 118784
    s_nop 0
    buffer_load_dwordx4 v21, s[48:51], s93 offen  lds
    s_add_u32 m0, s91, 135168
    s_nop 0
    buffer_load_dwordx4 v21, s[52:55], s93 offen  lds
    s_add_u32 m0, s91, 106496
    s_nop 0
    buffer_load_dwordx4 v18, s[36:39], s92 offen  lds
    s_add_u32 m0, s91, 110592
    s_nop 0
    buffer_load_dwordx4 v19, s[36:39], s92 offen  lds
    s_add_u32 m0, s91, 122880
    s_nop 0
    buffer_load_dwordx4 v22, s[48:51], s93 offen  lds
    s_add_u32 m0, s91, 139264
    s_nop 0
    buffer_load_dwordx4 v22, s[52:55], s93 offen  lds
    s_add_u32 m0, s91, 126976
    s_nop 0
    buffer_load_dwordx4 v23, s[48:51], s93 offen  lds
    s_add_u32 m0, s91, 143360
    s_nop 0
    buffer_load_dwordx4 v23, s[52:55], s93 offen  lds
    s_mul_i32 s85, s81, 2080
    s_add_u32 s85, s85, 147456
    v_lshl_add_u32 v4, v1, 4, s85
    ds_read_b128 v[48:51], v4
    ds_read_b128 v[52:55], v4 offset:1040
    v_lshrrev_b32 v4, 3, v1
    v_lshlrev_b32 v4, 12, v4
    v_and_b32 v5, 7, v1
    v_lshl_add_u32 v4, v5, 4, v4
    s_lshl_b32 s85, s4, 18
    s_lshl_b32 s86, s81, 16
    s_add_u32 s85, s85, s86
    s_lshl_b32 s86, s5, 7
    s_sub_u32 s86, 3968, s86
    s_add_u32 s85, s85, s86
    s_add_u32 s86, s85, 32768
    s_waitcnt lgkmcnt(0)
    buffer_store_dwordx4 v[48:51], v4, s[40:43], s85 offen sc1
    buffer_store_dwordx4 v[52:55], v4, s[40:43], s86 offen sc1
    s_waitcnt vmcnt(14)
    s_mov_b32 s33, 262144
L_nagain_2:
    v_cmp_gt_i32 vcc, 0, v193
    s_cbranch_vccnz L_nok_1
    buffer_load_dwordx2 v[192:193], off, s[72:75], 0 sc1
    s_sub_u32 s33, s33, 1
    s_waitcnt vmcnt(0)
    s_cbranch_scc0 L_nagain_2
L_nok_1:
    v_readfirstlane_b32 s82, v192
    v_readfirstlane_b32 s83, v193
    v_mov_b32 v4, 162944
    ds_write_b64 v4, v[192:193]
    v_mov_b32 v188, s82
    v_mov_b32 v189, s83
    s_mov_b64 exec, 1
    buffer_store_dwordx2 v[188:189], off, s[40:43], s89 sc1
    s_mov_b64 exec, -1
    s_barrier
    s_xor_b32 s92, s76, 6
    s_add_u32 s92, s95, s92
    s_and_b32 s92, s92, 7
    s_mul_i32 s93, s92, 229376
    s_lshl_b32 s92, s92, 7
    s_add_u32 s92, s92, s77
    s_add_u32 s93, s93, s78
    s_add_u32 m0, s91, 0
    s_nop 0
    buffer_load_dwordx4 v16, s[36:39], s92 offen  lds
    s_add_u32 m0, s91, 16384
    s_nop 0
    buffer_load_dwordx4 v20, s[48:51], s93 offen  lds
    s_add_u32 m0, s91, 32768
    s_nop 0
    buffer_load_dwordx4 v20, s[52:55], s93 offen  lds
    s_add_u32 m0, s91, 4096
    s_nop 0
    buffer_load_dwordx4 v17, s[36:39], s92 offen  lds
    s_add_u32 m0, s91, 20480
    s_nop 0
    buffer_load_dwordx4 v21, s[48:51], s93 offen  lds
    s_add_u32 m0, s91, 36864
    s_nop 0
    buffer_load_dwordx4 v21, s[52:55], s93 offen  lds
    s_add_u32 m0, s91, 8192
    s_nop 0
    buffer_load_dwordx4 v18, s[36:39], s92 offen  lds
    s_add_u32 m0, s91, 12288
    s_nop 0
    buffer_load_dwordx4 v19, s[36:39], s92 offen  lds
    s_add_u32 m0, s91, 24576
    s_nop 0
    buffer_load_dwordx4 v22, s[48:51], s93 offen  lds
    s_add_u32 m0, s91, 40960
    s_nop 0
    buffer_load_dwordx4 v22, s[52:55], s93 offen  lds
    s_add_u32 m0, s91, 28672
    s_nop 0
    buffer_load_dwordx4 v23, s[48:51], s93 offen  lds
    s_add_u32 m0, s91, 45056
    s_nop 0
    buffer_load_dwordx4 v23, s[52:55], s93 offen  lds
    s_lshl_b32 s87, s34, 3
    s_add_u32 s87, s87, s7
    s_lshl_b32 s87, s87, 2
    s_add_u32 s87, s87, s81
    s_lshl_b32 s88, s87, 7
    s_add_u32 s88, s88, 12877824
    v_lshl_add_u32 v5, v1, 3, s88
    s_lshl_b32 s88, s6, 6
    s_lshl_b32 s85, s81, 4
    s_add_u32 s88, s88, s85
    s_add_u32 s88, s88, 12894208
    v_and_b32 v4, 1, v1
    v_lshl_add_u32 v4, v4, 3, s88
    v_cmp_gt_u32 vcc, 16, v1
    s_lshl_b32 s87, s87, 12
    s_add_u32 s87, s87, 12582912
    v_cndmask_b32 v194, v4, v5, vcc
    s_waitcnt vmcnt(13)
    s_barrier
    s_xor_b32 s92, s76, 7
    s_add_u32 s92, s95, s92
    s_and_b32 s92, s92, 7
    s_mul_i32 s93, s92, 229376
    s_lshl_b32 s92, s92, 7
    s_add_u32 s92, s92, s77
    s_add_u32 s93, s93, s78
    s_add_u32 m0, s91, 49152
    s_nop 0
    buffer_load_dwordx4 v16, s[36:39], s92 offen  lds
    s_add_u32 m0, s91, 65536
    s_nop 0
    buffer_load_dwordx4 v20, s[48:51], s93 offen  lds
    s_add_u32 m0, s91, 81920
    s_nop 0
    buffer_load_dwordx4 v20, s[52:55], s93 offen  lds
    s_add_u32 m0, s91, 53248
    s_nop 0
    buffer_load_dwordx4 v17, s[36:39], s92 offen  lds
    s_add_u32 m0, s91, 69632
    s_nop 0
    buffer_load_dwordx4 v21, s[48:51], s93 offen  lds
    s_add_u32 m0, s91, 86016
    s_nop 0
    buffer_load_dwordx4 v21, s[52:55], s93 offen  lds
    s_add_u32 m0, s91, 57344
    s_nop 0
    buffer_load_dwordx4 v18, s[36:39], s92 offen  lds
    s_add_u32 m0, s91, 61440
    s_nop 0
    buffer_load_dwordx4 v19, s[36:39], s92 offen  lds
    s_add_u32 m0, s91, 73728
    s_nop 0
    buffer_load_dwordx4 v22, s[48:51], s93 offen  lds
    s_add_u32 m0, s91, 90112
    s_nop 0
    buffer_load_dwordx4 v22, s[52:55], s93 offen  lds
    s_add_u32 m0, s91, 77824
    s_nop 0
    buffer_load_dwordx4 v23, s[48:51], s93 offen  lds
    s_add_u32 m0, s91, 94208
    s_nop 0
    buffer_load_dwordx4 v23, s[52:55], s93 offen  lds
    s_lshl_b32 s85, s4, 2
    s_add_u32 s85, s85, s81
    s_lshl_b32 s85, s85, 5
    s_add_u32 s85, s85, s5
    s_lshl_b32 s85, s85, 2
    s_add_u32 s85, s85, 12861440
    v_mov_b32 v188, s82
    s_mov_b64 exec, 1
    buffer_store_dword v188, off, s[40:43], s85 sc1
    s_mov_b64 exec, -1
    s_lshl_b32 s89, s4, 2
    s_add_u32 s89, s89, s81
    s_lshl_b32 s89, s89, 7
    s_add_u32 s89, s89, 12861440
    s_mov_b32 s96, s82
    s_mov_b32 s97, s82
    s_lshr_b32 s85, s81, 1
    s_mul_i32 s86, s85, 4608
    s_add_u32 s86, s86, 82432
    v_lshl_add_u32 v14, v1, 4, s86
    v_and_b32 v5, 15, v1
    v_lshrrev_b32 v6, 4, v1
    v_lshlrev_b32 v7, 1, v5
    v_sub_u32 v7, v6, v7
    v_add_u32 v7, 30, v7
    v_lshl_add_u32 v11, v7, 4, s86
    v_lshlrev_b32 v7, 2, v5
    v_add_u32 v7, v7, v6
    v_lshlrev_b32 v13, 3, v7
    s_and_b32 s33, s81, 1
    s_lshl_b32 s93, s33, 11
    s_sub_u32 s86, s86, s93
    s_add_u32 s86, s86, 2552
    v_sub_u32 v12, s86, v13
    v_add_u32 v5, 1, v5
    v_and_b32 v7, 3, v5
    v_sub_u32 v5, v5, v7
    v_lshl_add_u32 v5, v6, 3, v5
    v_lshlrev_b32 v5, 1, v5
    v_mul_u32_u24 v7, 4160, v7
    s_mul_i32 s86, s85, 16640
    s_lshl_b32 s93, s33, 8
    s_add_u32 s86, s86, s93
    s_add_u32 s86, s86, 49152
    v_add3_u32 v10, v5, v7, s86
    v_add_u32 v11, s93, v11
    s_mov_b32 s92, s32
    s_waitcnt vmcnt(13)
    s_barrier
    buffer_load_dwordx2 v[196:197], v194, s[40:43], 0 offen sc1
    s_waitcnt vmcnt(2)
    v_mov_b32 v5, 7
    ds_write_b32 v27, v5
    s_lshr_b32 s85, s81, 1
    s_add_u32 s94, s94, s85
    s_lshl_b32 s85, s85, 12
    s_add_u32 s68, s68, s85
    s_addc_u32 s69, s69, 0
    s_and_b32 s85, s81, 1
    s_lshl_b32 s85, s85, 11
    v_lshl_add_u32 v190, v1, 4, s85
    buffer_load_dwordx4 v[148:151], v190, s[68:71], 0 offen offset:0
    buffer_load_dwordx4 v[152:155], v190, s[68:71], 0 offen offset:4
    buffer_load_dwordx4 v[156:159], v190, s[68:71], 0 offen offset:8
    buffer_load_dwordx4 v[160:163], v190, s[68:71], 0 offen offset:1024
    buffer_load_dwordx4 v[164:167], v190, s[68:71], 0 offen offset:1028
    buffer_load_dwordx4 v[168:171], v190, s[68:71], 0 offen offset:1032
    s_waitcnt vmcnt(6)
    v_cmp_ne_u64 vcc, s[82:83], v[196:197]
    s_cbranch_vccz L_pok_3
    s_mov_b32 s33, 262144
L_pagain_4:
    s_sub_u32 s33, s33, 1
    s_cbranch_scc1 L_pok_3
    s_sleep 6
    buffer_load_dwordx2 v[196:197], v194, s[40:43], 0 offen sc1
    s_waitcnt vmcnt(0)
    v_cmp_ne_u64 vcc, s[82:83], v[196:197]
    s_cbranch_vccnz L_pagain_4
L_pok_3:
    v_lshlrev_b32 v4, 4, v1
    buffer_load_dwordx4 v[208:211], v4, s[40:43], s87 offen offset:0 sc1
    buffer_load_dwordx4 v[212:215], v4, s[40:43], s87 offen offset:1024 sc1
    buffer_load_dwordx4 v[216:219], v4, s[40:43], s87 offen offset:2048 sc1
    buffer_load_dwordx4 v[220:223], v4, s[40:43], s87 offen offset:3072 sc1
    s_lshl_b32 s85, s6, 10
    s_lshl_b32 s86, s81, 8
    s_add_u32 s85, s85, s86
    s_add_u32 s85, s85, 12845056
    v_and_b32 v2, 31, v1
    v_lshlrev_b32 v2, 3, v2
    buffer_load_dwordx2 v[200:201], v2, s[40:43], s85 offen sc1
    s_lshl_b32 s86, s92, 16
    s_add_u32 m0, s90, 98304
    s_add_u32 s92, s92, 1
    s_cmp_eq_u32 s92, 7
    s_cselect_b32 s92, 0, s92
    buffer_load_dwordx4 v15, s[28:31], s86 offen  lds
    s_add_u32 m0, s90, 99328
    s_add_u32 s86, s86, 8192
    buffer_load_dwordx4 v15, s[28:31], s86 offen  lds
    s_add_u32 m0, s90, 100352
    s_add_u32 s86, s86, 8192
    buffer_load_dwordx4 v15, s[28:31], s86 offen  lds
    s_add_u32 m0, s90, 101376
    s_add_u32 s86, s86, 8192
    buffer_load_dwordx4 v15, s[28:31], s86 offen  lds
    s_lshl_b32 s86, s92, 16
    s_add_u32 m0, s90, 102400
    s_add_u32 s92, s92, 1
    s_cmp_eq_u32 s92, 7
    s_cselect_b32 s92, 0, s92
    buffer_load_dwordx4 v15, s[28:31], s86 offen  lds
    s_add_u32 m0, s90, 103424
    s_add_u32 s86, s86, 8192
    buffer_load_dwordx4 v15, s[28:31], s86 offen  lds
    s_add_u32 m0, s90, 104448
    s_add_u32 s86, s86, 8192
    buffer_load_dwordx4 v15, s[28:31], s86 offen  lds
    s_add_u32 m0, s90, 105472
    s_add_u32 s86, s86, 8192
    buffer_load_dwordx4 v15, s[28:31], s86 offen  lds
    s_lshl_b32 s85, s81, 8
    s_add_u32 s86, s85, 160896
    v_add_u32 v2, s86, v2
    v_and_b32 v4, 15, v1
    v_lshlrev_b32 v4, 4, v4
    v_lshrrev_b32 v5, 4, v1
    v_lshl_add_u32 v4, v5, 2, v4
    s_add_u32 s86, s85, 161920
    v_add_u32 v4, s86, v4
    s_waitcnt vmcnt(8)
    ds_write_b64 v2, v[200:201]
    v_add_f32 v208, v208, v212
    v_add_f32 v209, v209, v213
    v_add_f32 v210, v210, v214
    v_add_f32 v211, v211, v215
    v_add_f32 v216, v216, v220
    v_add_f32 v217, v217, v221
    v_add_f32 v218, v218, v222
    v_add_f32 v219, v219, v223
    v_add_f32 v208, v208, v216
    v_add_f32 v209, v209, v217
    v_add_f32 v210, v210, v218
    v_add_f32 v211, v211, v219
    s_nop 1
    v_permlane32_swap_b32 v208, v210
    v_permlane32_swap_b32 v209, v211
    v_add_f32 v208, v208, v210
    v_add_f32 v209, v209, v211
    s_nop 1
    v_permlane16_swap_b32 v208, v209
    v_add_f32 v208, v208, v209
    ds_write_b32 v4, v208
    s_waitcnt lgkmcnt(0)
    v_mov_b32 v5, 8
    ds_write_b32 v27, v5
    s_load_dwordx16 s[48:63], s[40:41], s89 glc
    s_add_u32 s85, s89, 64
    s_load_dwordx16 s[64:79], s[40:41], s85 glc
    s_setprio 1
    s_lshl_b32 s86, s92, 16
    s_add_u32 m0, s90, 106496
    s_add_u32 s92, s92, 1
    s_cmp_eq_u32 s92, 7
    s_cselect_b32 s92, 0, s92
    buffer_load_dwordx4 v15, s[28:31], s86 offen  lds
    s_add_u32 m0, s90, 107520
    s_add_u32 s86, s86, 8192
    buffer_load_dwordx4 v15, s[28:31], s86 offen  lds
    s_add_u32 m0, s90, 108544
    s_add_u32 s86, s86, 8192
    buffer_load_dwordx4 v15, s[28:31], s86 offen  lds
    s_add_u32 m0, s90, 109568
    s_add_u32 s86, s86, 8192
    buffer_load_dwordx4 v15, s[28:31], s86 offen  lds
    v_alignbit_b32 v172, v152, v148, 16
    v_alignbit_b32 v176, v156, v152, 16
    v_alignbit_b32 v173, v153, v149, 16
    v_alignbit_b32 v177, v157, v153, 16
    v_alignbit_b32 v174, v154, v150, 16
    v_alignbit_b32 v178, v158, v154, 16
    v_alignbit_b32 v175, v155, v151, 16
    v_alignbit_b32 v179, v159, v155, 16
    v_alignbit_b32 v180, v164, v160, 16
    v_alignbit_b32 v184, v168, v164, 16
    v_alignbit_b32 v181, v165, v161, 16
    v_alignbit_b32 v185, v169, v165, 16
    v_alignbit_b32 v182, v166, v162, 16
    v_alignbit_b32 v186, v170, v166, 16
    v_alignbit_b32 v183, v167, v163, 16
    v_alignbit_b32 v187, v171, v167, 16
    v_mov_b32 v4, 163040
L_qagain_6:
    ds_read_b128 v[6:9], v4
    s_waitcnt lgkmcnt(0)
    v_min3_u32 v6, v6, v7, v8
    v_min_u32 v6, v6, v9
    v_cmp_le_u32 vcc, 7, v6
    s_cbranch_vccnz L_qok_5
    s_sleep 1
    s_branch L_qagain_6
L_qok_5:
    s_xor_b64 s[48:49], s[48:49], s[96:97]
    s_xor_b64 s[50:51], s[50:51], s[96:97]
    s_or_b64 s[48:49], s[48:49], s[50:51]
    s_xor_b64 s[52:53], s[52:53], s[96:97]
    s_or_b64 s[48:49], s[48:49], s[52:53]
    s_xor_b64 s[54:55], s[54:55], s[96:97]
    s_or_b64 s[48:49], s[48:49], s[54:55]
    s_xor_b64 s[56:57], s[56:57], s[96:97]
    s_or_b64 s[48:49], s[48:49], s[56:57]
    s_xor_b64 s[58:59], s[58:59], s[96:97]
    s_or_b64 s[48:49], s[48:49], s[58:59]
    s_xor_b64 s[60:61], s[60:61], s[96:97]
    s_or_b64 s[48:49], s[48:49], s[60:61]
    s_xor_b64 s[62:63], s[62:63], s[96:97]
    s_or_b64 s[48:49], s[48:49], s[62:63]
    s_xor_b64 s[64:65], s[64:65], s[96:97]
    s_or_b64 s[48:49], s[48:49], s[64:65]
    s_xor_b64 s[66:67], s[66:67], s[96:97]
    s_or_b64 s[48:49], s[48:49], s[66:67]
    s_xor_b64 s[68:69], s[68:69], s[96:97]
    s_or_b64 s[48:49], s[48:49], s[68:69]
    s_xor_b64 s[70:71], s[70:71], s[96:97]
    s_or_b64 s[48:49], s[48:49], s[70:71]
    s_xor_b64 s[72:73], s[72:73], s[96:97]
    s_or_b64 s[48:49], s[48:49], s[72:73]
    s_xor_b64 s[74:75], s[74:75], s[96:97]
    s_or_b64 s[48:49], s[48:49], s[74:75]
    s_xor_b64 s[76:77], s[76:77], s[96:97]
    s_or_b64 s[48:49], s[48:49], s[76:77]
    s_xor_b64 s[78:79], s[78:79], s[96:97]
    s_or_b64 s[48:49], s[48:49], s[78:79]
    s_cselect_b32 s88, 1, 0
    s_lshl_b32 s86, s92, 16
    s_add_u32 m0, s90, 0
    s_add_u32 s92, s92, 1
    s_cmp_eq_u32 s92, 7
    s_cselect_b32 s92, 0, s92
    buffer_load_dwordx4 v15, s[28:31], s86 offen  lds
    s_add_u32 m0, s90, 1024
    s_add_u32 s86, s86, 8192
    buffer_load_dwordx4 v15, s[28:31], s86 offen  lds
    s_add_u32 m0, s90, 2048
    s_add_u32 s86, s86, 8192
    buffer_load_dwordx4 v15, s[28:31], s86 offen  lds
    s_add_u32 m0, s90, 3072
    s_add_u32 s86, s86, 8192
    buffer_load_dwordx4 v15, s[28:31], s86 offen  lds
    s_lshl_b32 s86, s92, 16
    s_add_u32 m0, s90, 4096
    s_add_u32 s92, s92, 1
    s_cmp_eq_u32 s92, 7
    s_cselect_b32 s92, 0, s92
    buffer_load_dwordx4 v15, s[28:31], s86 offen  lds
    s_add_u32 m0, s90, 5120
    s_add_u32 s86, s86, 8192
    buffer_load_dwordx4 v15, s[28:31], s86 offen  lds
    s_add_u32 m0, s90, 6144
    s_add_u32 s86, s86, 8192
    buffer_load_dwordx4 v15, s[28:31], s86 offen  lds
    s_add_u32 m0, s90, 7168
    s_add_u32 s86, s86, 8192
    buffer_load_dwordx4 v15, s[28:31], s86 offen  lds
    s_lshl_b32 s86, s92, 16
    s_add_u32 m0, s90, 8192
    s_add_u32 s92, s92, 1
    s_cmp_eq_u32 s92, 7
    s_cselect_b32 s92, 0, s92
    buffer_load_dwordx4 v15, s[28:31], s86 offen  lds
    s_add_u32 m0, s90, 9216
    s_add_u32 s86, s86, 8192
    buffer_load_dwordx4 v15, s[28:31], s86 offen  lds
    s_add_u32 m0, s90, 10240
    s_add_u32 s86, s86, 8192
    buffer_load_dwordx4 v15, s[28:31], s86 offen  lds
    s_add_u32 m0, s90, 11264
    s_add_u32 s86, s86, 8192
    buffer_load_dwordx4 v15, s[28:31], s86 offen  lds
    s_cmp_lg_u32 s88, 0
    s_cbranch_scc1 L_ulate
    s_lshl_b32 s85, s94, 12
    v_lshlrev_b32 v4, 4, v1
    buffer_load_dwordx4 v[48:51], v4, s[40:43], s85 offen offset:0 sc1
    buffer_load_dwordx4 v[52:55], v4, s[40:43], s85 offen offset:1024 sc1
    buffer_load_dwordx4 v[56:59], v4, s[40:43], s85 offen offset:2048 sc1
    buffer_load_dwordx4 v[60:63], v4, s[40:43], s85 offen offset:3072 sc1
L_ulate:
    v_mov_b32 v4, 163040
L_qagain_8:
    ds_read_b128 v[6:9], v4
    s_waitcnt lgkmcnt(0)
    v_min3_u32 v6, v6, v7, v8
    v_min_u32 v6, v6, v9
    v_cmp_le_u32 vcc, 8, v6
    s_cbranch_vccnz L_qok_7
    s_sleep 1
    s_branch L_qagain_8
L_qok_7:
    s_lshr_b32 s85, s81, 1
    s_mul_i32 s86, s85, 16640
    s_add_u32 s86, s86, 49184
    v_add_u32 v4, s86, v190
    ds_write_b128 v4, v[148:151] offset:0
    ds_write_b128 v4, v[172:175] offset:4160
    ds_write_b128 v4, v[152:155] offset:8320
    ds_write_b128 v4, v[176:179] offset:12480
    ds_write_b128 v4, v[160:163] offset:1024
    ds_write_b128 v4, v[180:183] offset:5184
    ds_write_b128 v4, v[164:167] offset:9344
    ds_write_b128 v4, v[184:187] offset:13504
    v_mov_b32 v76, 0
    v_mov_b32 v77, 0
    v_mov_b32 v78, 0
    v_mov_b32 v79, 0
    s_mul_i32 s86, s85, 4608
    s_add_u32 s86, s86, 86528
    v_and_b32 v5, 31, v1
    v_lshl_add_u32 v5, v5, 4, s86
    ds_write_b128 v5, v[76:79]
    s_bitcmp1_b32 s81, 0
    s_cbranch_scc1 L_hf_9
    v_mov_b32 v80, 0
    v_mov_b32 v81, 0
    v_mov_b32 v82, 0
    v_mov_b32 v83, 0
    v_mov_b32 v84, 0
    v_mov_b32 v85, 0
    v_mov_b32 v86, 0
    v_mov_b32 v87, 0
    v_mov_b32 v88, 0
    v_mov_b32 v89, 0
    v_mov_b32 v90, 0
    v_mov_b32 v91, 0
    v_lshlrev_b32 v83, 16, v148
    v_mov_b32 v87, v148
    v_lshlrev_b32 v90, 16, v148
    v_mov_b32 v91, v172
    v_subrev_u32 v4, 32, v4
    s_mov_b64 exec, 1
    ds_write_b128 v4, v[76:79] offset:0
    ds_write_b128 v4, v[76:79] offset:16
    ds_write_b128 v4, v[76:79] offset:4160
    ds_write_b128 v4, v[80:83] offset:4176
    ds_write_b128 v4, v[76:79] offset:8320
    ds_write_b128 v4, v[84:87] offset:8336
    ds_write_b128 v4, v[76:79] offset:12480
    ds_write_b128 v4, v[88:91] offset:12496
    s_mov_b64 exec, -1
L_hf_9:
    v_lshlrev_b32 v4, 4, v1
    s_cmp_eq_u32 s88, 0
    s_cbranch_scc1 L_conv
    s_mov_b32 s33, 262144
L_sagain_11:
    s_load_dwordx16 s[48:63], s[40:41], s89 glc
    s_add_u32 s85, s89, 64
    s_load_dwordx16 s[64:79], s[40:41], s85 glc
    s_sub_u32 s33, s33, 1
    s_cbranch_scc1 L_sok_10
    s_waitcnt lgkmcnt(0)
    s_xor_b64 s[48:49], s[48:49], s[96:97]
    s_xor_b64 s[50:51], s[50:51], s[96:97]
    s_or_b64 s[48:49], s[48:49], s[50:51]
    s_xor_b64 s[52:53], s[52:53], s[96:97]
    s_or_b64 s[48:49], s[48:49], s[52:53]
    s_xor_b64 s[54:55], s[54:55], s[96:97]
    s_or_b64 s[48:49], s[48:49], s[54:55]
    s_xor_b64 s[56:57], s[56:57], s[96:97]
    s_or_b64 s[48:49], s[48:49], s[56:57]
    s_xor_b64 s[58:59], s[58:59], s[96:97]
    s_or_b64 s[48:49], s[48:49], s[58:59]
    s_xor_b64 s[60:61], s[60:61], s[96:97]
    s_or_b64 s[48:49], s[48:49], s[60:61]
    s_xor_b64 s[62:63], s[62:63], s[96:97]
    s_or_b64 s[48:49], s[48:49], s[62:63]
    s_xor_b64 s[64:65], s[64:65], s[96:97]
    s_or_b64 s[48:49], s[48:49], s[64:65]
    s_xor_b64 s[66:67], s[66:67], s[96:97]
    s_or_b64 s[48:49], s[48:49], s[66:67]
    s_xor_b64 s[68:69], s[68:69], s[96:97]
    s_or_b64 s[48:49], s[48:49], s[68:69]
    s_xor_b64 s[70:71], s[70:71], s[96:97]
    s_or_b64 s[48:49], s[48:49], s[70:71]
    s_xor_b64 s[72:73], s[72:73], s[96:97]
    s_or_b64 s[48:49], s[48:49], s[72:73]
    s_xor_b64 s[74:75], s[74:75], s[96:97]
    s_or_b64 s[48:49], s[48:49], s[74:75]
    s_xor_b64 s[76:77], s[76:77], s[96:97]
    s_or_b64 s[48:49], s[48:49], s[76:77]
    s_xor_b64 s[78:79], s[78:79], s[96:97]
    s_or_b64 s[48:49], s[48:49], s[78:79]
    s_cbranch_scc0 L_sok_10
    s_sleep 4
    s_branch L_sagain_11
L_sok_10:
    s_lshl_b32 s85, s94, 12
    v_lshlrev_b32 v4, 4, v1
    buffer_load_dwordx4 v[48:51], v4, s[40:43], s85 offen offset:0 sc1
    buffer_load_dwordx4 v[52:55], v4, s[40:43], s85 offen offset:1024 sc1
    buffer_load_dwordx4 v[56:59], v4, s[40:43], s85 offen offset:2048 sc1
    buffer_load_dwordx4 v[60:63], v4, s[40:43], s85 offen offset:3072 sc1
    s_waitcnt vmcnt(0)
    s_branch L_conv
L_cstart:
    s_cmp_lg_u32 s3, 0
    s_cbranch_scc1 L_sj1_12
    v_mov_b32 v6, 162944
    v_mov_b32 v4, 0
    v_mov_b32 v5, 0
    ds_write_b64 v6, v[4:5] offset:8
    ds_write_b64 v6, v[4:5] offset:16
    ds_write_b64 v6, v[4:5] offset:24
    ds_write_b64 v6, v[4:5] offset:32
    ds_write_b64 v6, v[4:5] offset:40
    ds_write_b64 v6, v[4:5] offset:48
    ds_write_b64 v6, v[4:5] offset:56
    ds_write_b64 v6, v[4:5] offset:64
    ds_write_b64 v6, v[4:5] offset:72
    ds_write_b64 v6, v[4:5] offset:80
    ds_write_b64 v6, v[4:5] offset:88
    ds_write_b64 v6, v[4:5] offset:96
    ds_write_b64 v6, v[4:5] offset:104
    ds_write_b64 v6, v[4:5] offset:112
    ds_write_b64 v6, v[4:5] offset:120
    ds_write_b64 v6, v[4:5] offset:128
    ds_write_b64 v6, v[4:5] offset:136
L_sj1_12:
    s_cmp_lg_u32 s3, 1
    s_cbranch_scc1 L_sj2_13
    s_cmp_lg_u32 s2, 0
    s_cbranch_scc1 L_sj2_13
    s_mov_b32 s74, 256
    s_mov_b32 s75, 0x20000
    s_memrealtime s[86:87]
    s_waitcnt lgkmcnt(0)
    s_or_b32 s87, s87, 0x80000000
    v_mov_b32 v4, s86
    v_mov_b32 v5, s87
    s_mov_b64 exec, 1
    buffer_store_dwordx2 v[4:5], off, s[72:75], 0 sc1
    s_mov_b64 exec, -1
L_sj2_13:
    s_load_dwordx2 s[40:41], s[0:1], 96
    s_load_dwordx2 s[68:69], s[0:1], 32
    s_load_dwordx2 s[96:97], s[0:1], 40
    s_load_dwordx2 s[28:29], s[0:1], 72
    s_load_dwordx2 s[44:45], s[0:1], 80
    s_mov_b32 s42, 16777216
    s_mov_b32 s43, 0x20000
    s_mov_b32 s70, 4096
    s_mov_b32 s71, 0x20000
    s_mov_b32 s30, 1835008
    s_mov_b32 s31, 0x20000
    s_mov_b32 s46, 2097152
    s_mov_b32 s47, 0x20000
    s_mov_b32 s74, 256
    s_mov_b32 s75, 0x20000
    s_mov_b32 s38, 2097152
    s_mov_b32 s39, 0x20000
    s_lshl_b32 s80, s6, 1
    s_add_u32 s80, s80, s34
    s_lshl_b32 s87, s79, 1
    s_add_u32 s32, s7, s87
    s_add_u32 s32, s32, s4
    s_cmp_ge_u32 s32, 7
    s_cselect_b32 s87, 7, 0
    s_sub_u32 s32, s32, s87
    s_cmp_ge_u32 s32, 7
    s_cselect_b32 s87, 7, 0
    s_sub_u32 s32, s32, s87
    s_waitcnt lgkmcnt(0)
    s_and_b32 s85, s3, 1
    s_lshr_b32 s86, s3, 1
    s_lshl_b32 s88, s7, 1
    s_add_u32 s88, s88, s86
    s_cmp_ge_u32 s88, 7
    s_cselect_b32 s87, 25, 0
    s_add_u32 s88, s88, s87
    s_lshl_b32 s48, s6, 1
    s_add_u32 s48, s48, s85
    s_lshl_b32 s48, s48, 1
    s_add_u32 s48, s48, s34
    s_lshl_b32 s48, s48, 6
    s_add_u32 s48, s48, s88
    s_lshl_b32 s48, s48, 3
    s_add_u32 s48, s48, 12910592
    s_lshl_b32 s49, s80, 2
    s_add_u32 s49, s49, s3
    s_lshl_b32 s49, s49, 8
    s_add_u32 s49, s49, 12910592
    s_mul_i32 s50, s80, 224
    s_mul_i32 s88, s81, 14
    s_add_u32 s50, s50, s88
    s_lshl_b32 s50, s50, 10
    s_add_u32 s50, s50, 4194304
    s_lshl_b32 s51, s81, 2
    s_add_u32 s51, s51, 162960
    s_lshl_b32 s52, s6, 1
    s_add_u32 s52, s52, s85
    s_mul_i32 s52, s52, 224
    s_lshl_b32 s88, s35, 2
    s_add_u32 s52, s52, s88
    s_lshl_b32 s88, s86, 1
    s_add_u32 s52, s52, s88
    s_lshl_b32 s52, s52, 10
    s_add_u32 s52, s52, 4194304
    s_add_u32 s53, s52, 57344
    s_add_u32 s54, s52, 114688
    s_add_u32 s55, s52, 172032
    s_mov_b32 s89, s85
    s_mov_b32 s88, s86
    v_lshrrev_b32 v4, 3, v1
    v_bfe_u32 v5, v1, 4, 2
    v_lshlrev_b32 v5, 1, v5
    v_and_b32 v6, 7, v1
    v_xor_b32 v5, v5, v6
    v_lshlrev_b32 v4, 10, v4
    v_lshl_add_u32 v9, v5, 4, v4
    s_mul_i32 s85, s81, 458752
    s_lshl_b32 s86, s7, 7
    s_add_u32 s85, s85, s86
    v_add_u32 v9, s85, v9
    v_lshrrev_b32 v21, 4, v1
    v_bfe_u32 v16, v1, 2, 2
    v_and_b32 v18, 3, v1
    v_lshlrev_b32 v18, 3, v18
    v_lshl_add_u32 v19, v21, 2, v16
    v_bfe_u32 v17, v19, 1, 2
    v_lshl_add_u32 v19, v19, 7, v18
    s_mul_i32 s87, s81, 12288
    v_add_u32 v19, s87, v19
    v_xor_b32 v20, 0, v17
    v_lshl_add_u32 v2, v20, 5, v19
    v_xor_b32 v20, 1, v17
    v_lshl_add_u32 v3, v20, 5, v19
    v_xor_b32 v20, 2, v17
    v_lshl_add_u32 v7, v20, 5, v19
    v_xor_b32 v20, 3, v17
    v_lshl_add_u32 v8, v20, 5, v19
    v_lshlrev_b32 v6, 4, v1
    s_cmp_eq_u32 s7, 7
    s_cbranch_scc1 L_cspare
    v_and_b32 v22, 15, v1
    v_lshrrev_b32 v17, 1, v22
    s_lshl_b32 s87, s89, 13
    v_lshl_add_u32 v19, v22, 7, s87
    v_add_u32 v20, 0, v21
    v_xor_b32 v20, v20, v17
    v_lshl_add_u32 v14, v20, 4, v19
    v_add_u32 v20, 4, v21
    v_xor_b32 v20, v20, v17
    v_lshl_add_u32 v15, v20, 4, v19
    v_lshl_add_u32 v19, v21, 3, v16
    v_lshl_add_u32 v19, v19, 8, v18
    v_and_b32 v17, 1, v21
    v_lshl_add_u32 v17, v17, 2, v16
    s_lshl_b32 s87, s88, 2
    s_add_u32 s85, s87, 0
    v_xor_b32 v20, s85, v17
    v_lshl_add_u32 v10, v20, 5, v19
    s_add_u32 s85, s87, 1
    v_xor_b32 v20, s85, v17
    v_lshl_add_u32 v11, v20, 5, v19
    s_add_u32 s85, s87, 2
    v_xor_b32 v20, s85, v17
    v_lshl_add_u32 v12, v20, 5, v19
    s_add_u32 s85, s87, 3
    v_xor_b32 v20, s85, v17
    v_lshl_add_u32 v13, v20, 5, v19
    s_lshl_b32 s87, s89, 9
    s_add_u32 s87, s87, 160896
    v_lshl_add_u32 v4, v22, 3, s87
    s_lshl_b32 s87, s88, 8
    s_add_u32 s87, s87, 161920
    v_lshl_add_u32 v5, v21, 4, s87
    v_pk_mov_b32 v[128:129], 0, 0
    v_pk_mov_b32 v[130:131], 0, 0
    v_pk_mov_b32 v[132:133], 0, 0
    v_pk_mov_b32 v[134:135], 0, 0
    v_pk_mov_b32 v[136:137], 0, 0
    v_pk_mov_b32 v[138:139], 0, 0
    v_pk_mov_b32 v[140:141], 0, 0
    v_pk_mov_b32 v[142:143], 0, 0
    v_pk_mov_b32 v[144:145], 0, 0
    v_pk_mov_b32 v[146:147], 0, 0
    v_pk_mov_b32 v[148:149], 0, 0
    v_pk_mov_b32 v[150:151], 0, 0
    v_pk_mov_b32 v[152:153], 0, 0
    v_pk_mov_b32 v[154:155], 0, 0
    v_pk_mov_b32 v[156:157], 0, 0
    v_pk_mov_b32 v[158:159], 0, 0
    v_pk_mov_b32 v[160:161], 0, 0
    v_pk_mov_b32 v[162:163], 0, 0
    v_pk_mov_b32 v[164:165], 0, 0
    v_pk_mov_b32 v[166:167], 0, 0
    v_pk_mov_b32 v[168:169], 0, 0
    v_pk_mov_b32 v[170:171], 0, 0
    v_pk_mov_b32 v[172:173], 0, 0
    v_pk_mov_b32 v[174:175], 0, 0
    v_pk_mov_b32 v[176:177], 0, 0
    v_pk_mov_b32 v[178:179], 0, 0
    v_pk_mov_b32 v[180:181], 0, 0
    v_pk_mov_b32 v[182:183], 0, 0
    v_pk_mov_b32 v[184:185], 0, 0
    v_pk_mov_b32 v[186:187], 0, 0
    v_pk_mov_b32 v[188:189], 0, 0
    v_pk_mov_b32 v[190:191], 0, 0
    v_pk_mov_b32 v[192:193], 0, 0
    v_pk_mov_b32 v[194:195], 0, 0
    v_pk_mov_b32 v[196:197], 0, 0
    v_pk_mov_b32 v[198:199], 0, 0
    v_pk_mov_b32 v[200:201], 0, 0
    v_pk_mov_b32 v[202:203], 0, 0
    v_pk_mov_b32 v[204:205], 0, 0
    v_pk_mov_b32 v[206:207], 0, 0
    v_pk_mov_b32 v[208:209], 0, 0
    v_pk_mov_b32 v[210:211], 0, 0
    v_pk_mov_b32 v[212:213], 0, 0
    v_pk_mov_b32 v[214:215], 0, 0
    v_pk_mov_b32 v[216:217], 0, 0
    v_pk_mov_b32 v[218:219], 0, 0
    v_pk_mov_b32 v[220:221], 0, 0
    v_pk_mov_b32 v[222:223], 0, 0
    v_pk_mov_b32 v[224:225], 0, 0
    v_pk_mov_b32 v[226:227], 0, 0
    v_pk_mov_b32 v[228:229], 0, 0
    v_pk_mov_b32 v[230:231], 0, 0
    v_pk_mov_b32 v[232:233], 0, 0
    v_pk_mov_b32 v[234:235], 0, 0
    v_pk_mov_b32 v[236:237], 0, 0
    v_pk_mov_b32 v[238:239], 0, 0
    v_pk_mov_b32 v[240:241], 0, 0
    v_pk_mov_b32 v[242:243], 0, 0
    v_pk_mov_b32 v[244:245], 0, 0
    v_pk_mov_b32 v[246:247], 0, 0
    v_pk_mov_b32 v[248:249], 0, 0
    v_pk_mov_b32 v[250:251], 0, 0
    v_pk_mov_b32 v[252:253], 0, 0
    v_pk_mov_b32 v[254:255], 0, 0
    v_mov_b32 v112, 162944
    v_mov_b32 v113, 1
    s_lshl_b32 s87, s3, 2
    s_add_u32 s87, s87, 163040
    v_mov_b32 v114, s87
    s_mov_b32 s89, 0
    s_mov_b32 s90, 0
    s_mov_b32 s92, 4294868992
    s_mov_b32 s93, 49152
    s_waitcnt vmcnt(0) lgkmcnt(0)
    s_barrier
    ds_read_b128 v[48:51], v14 offset:0
    ds_read_b64_tr_b16 v[16:17], v10 offset:16384
    ds_read_b64_tr_b16 v[18:19], v10 offset:17408
    ds_read_b64_tr_b16 v[32:33], v10 offset:32768
    ds_read_b64_tr_b16 v[34:35], v10 offset:33792
    ds_read_b128 v[52:55], v14 offset:2048
    ds_read_b64_tr_b16 v[20:21], v11 offset:16384
    ds_read_b64_tr_b16 v[22:23], v11 offset:17408
    ds_read_b64_tr_b16 v[36:37], v11 offset:32768
    ds_read_b64_tr_b16 v[38:39], v11 offset:33792
    ds_read_b128 v[56:59], v14 offset:4096
    ds_read_b64_tr_b16 v[24:25], v12 offset:16384
    ds_read_b64_tr_b16 v[26:27], v12 offset:17408
    ds_read_b64_tr_b16 v[40:41], v12 offset:32768
    ds_read_b64_tr_b16 v[42:43], v12 offset:33792
    ds_read_b128 v[60:63], v14 offset:6144
    ds_read_b64_tr_b16 v[28:29], v13 offset:16384
    ds_read_b64_tr_b16 v[30:31], v13 offset:17408
    ds_read_b64_tr_b16 v[44:45], v13 offset:32768
    ds_read_b64_tr_b16 v[46:47], v13 offset:33792
    s_waitcnt lgkmcnt(0)
    v_mfma_f32_16x16x32_bf16 v[128:131], v[16:19], v[48:51], v[128:131]
    v_mfma_f32_16x16x32_bf16 v[136:139], v[32:35], v[48:51], v[136:139]
    v_mfma_f32_16x16x32_bf16 v[132:135], v[20:23], v[48:51], v[132:135]
    v_mfma_f32_16x16x32_bf16 v[140:143], v[36:39], v[48:51], v[140:143]
    v_mfma_f32_16x16x32_bf16 v[144:147], v[24:27], v[48:51], v[144:147]
    v_mfma_f32_16x16x32_bf16 v[152:155], v[40:43], v[48:51], v[152:155]
    v_mfma_f32_16x16x32_bf16 v[148:151], v[28:31], v[48:51], v[148:151]
    v_mfma_f32_16x16x32_bf16 v[156:159], v[44:47], v[48:51], v[156:159]
    v_mfma_f32_16x16x32_bf16 v[160:163], v[16:19], v[52:55], v[160:163]
    v_mfma_f32_16x16x32_bf16 v[168:171], v[32:35], v[52:55], v[168:171]
    v_mfma_f32_16x16x32_bf16 v[164:167], v[20:23], v[52:55], v[164:167]
    v_mfma_f32_16x16x32_bf16 v[172:175], v[36:39], v[52:55], v[172:175]
    v_mfma_f32_16x16x32_bf16 v[176:179], v[24:27], v[52:55], v[176:179]
    v_mfma_f32_16x16x32_bf16 v[184:187], v[40:43], v[52:55], v[184:187]
    v_mfma_f32_16x16x32_bf16 v[180:183], v[28:31], v[52:55], v[180:183]
    v_mfma_f32_16x16x32_bf16 v[188:191], v[44:47], v[52:55], v[188:191]
    v_mfma_f32_16x16x32_bf16 v[192:195], v[16:19], v[56:59], v[192:195]
    v_mfma_f32_16x16x32_bf16 v[200:203], v[32:35], v[56:59], v[200:203]
    v_mfma_f32_16x16x32_bf16 v[196:199], v[20:23], v[56:59], v[196:199]
    v_mfma_f32_16x16x32_bf16 v[204:207], v[36:39], v[56:59], v[204:207]
    v_mfma_f32_16x16x32_bf16 v[208:211], v[24:27], v[56:59], v[208:211]
    v_mfma_f32_16x16x32_bf16 v[216:219], v[40:43], v[56:59], v[216:219]
    v_mfma_f32_16x16x32_bf16 v[212:215], v[28:31], v[56:59], v[212:215]
    v_mfma_f32_16x16x32_bf16 v[220:223], v[44:47], v[56:59], v[220:223]
    s_barrier
    v_mfma_f32_16x16x32_bf16 v[224:227], v[16:19], v[60:63], v[224:227]
    ds_read_b128 v[96:99], v15 offset:0
    ds_read_b64_tr_b16 v[64:65], v10 offset:24576
    ds_read_b64_tr_b16 v[66:67], v10 offset:25600
    v_mfma_f32_16x16x32_bf16 v[232:235], v[32:35], v[60:63], v[232:235]
    ds_read_b64_tr_b16 v[80:81], v10 offset:40960
    ds_read_b64_tr_b16 v[82:83], v10 offset:41984
    ds_read_b128 v[100:103], v15 offset:2048
    v_mfma_f32_16x16x32_bf16 v[228:231], v[20:23], v[60:63], v[228:231]
    ds_read_b64_tr_b16 v[68:69], v11 offset:24576
    ds_read_b64_tr_b16 v[70:71], v11 offset:25600
    ds_read_b64_tr_b16 v[84:85], v11 offset:40960
    v_mfma_f32_16x16x32_bf16 v[236:239], v[36:39], v[60:63], v[236:239]
    ds_read_b64_tr_b16 v[86:87], v11 offset:41984
    ds_read_b128 v[104:107], v15 offset:4096
    ds_read_b64_tr_b16 v[72:73], v12 offset:24576
    v_mfma_f32_16x16x32_bf16 v[240:243], v[24:27], v[60:63], v[240:243]
    ds_read_b64_tr_b16 v[74:75], v12 offset:25600
    ds_read_b64_tr_b16 v[88:89], v12 offset:40960
    ds_read_b64_tr_b16 v[90:91], v12 offset:41984
    v_mfma_f32_16x16x32_bf16 v[248:251], v[40:43], v[60:63], v[248:251]
    ds_read_b128 v[108:111], v15 offset:6144
    ds_read_b64_tr_b16 v[76:77], v13 offset:24576
    ds_read_b64_tr_b16 v[78:79], v13 offset:25600
    v_mfma_f32_16x16x32_bf16 v[244:247], v[28:31], v[60:63], v[244:247]
    ds_read_b64_tr_b16 v[92:93], v13 offset:40960
    ds_read_b64_tr_b16 v[94:95], v13 offset:41984
    v_mfma_f32_16x16x32_bf16 v[252:255], v[44:47], v[60:63], v[252:255]
    ds_read_b128 v[116:119], v112 offset:80
    s_add_u32 s90, s90, 1
    s_cmp_eq_u32 s90, 3
    s_cselect_b32 s88, s92, s93
    s_cselect_b32 s90, 0, s90
    s_add_u32 s89, s89, 1
    v_add_u32 v10, s88, v10
    v_add_u32 v11, s88, v11
    v_add_u32 v12, s88, v12
    v_add_u32 v13, s88, v13
    v_add_u32 v14, s88, v14
    v_add_u32 v15, s88, v15
    s_branch L_cg1_in
.p2align 3
L_cg1:
    v_mfma_f32_16x16x32_bf16 v[136:139], v[80:83], v[96:99], v[136:139]
    ds_read_b128 v[48:51], v14 offset:0
    v_mfma_f32_16x16x32_bf16 v[132:135], v[68:71], v[96:99], v[132:135]
    ds_read_b64_tr_b16 v[16:17], v10 offset:16384
    v_mfma_f32_16x16x32_bf16 v[140:143], v[84:87], v[96:99], v[140:143]
    ds_read_b64_tr_b16 v[18:19], v10 offset:17408
    v_mfma_f32_16x16x32_bf16 v[144:147], v[72:75], v[96:99], v[144:147]
    ds_read_b64_tr_b16 v[32:33], v10 offset:32768
    v_mfma_f32_16x16x32_bf16 v[152:155], v[88:91], v[96:99], v[152:155]
    ds_read_b64_tr_b16 v[34:35], v10 offset:33792
    v_mfma_f32_16x16x32_bf16 v[148:151], v[76:79], v[96:99], v[148:151]
    ds_read_b128 v[52:55], v14 offset:2048
    v_mfma_f32_16x16x32_bf16 v[156:159], v[92:95], v[96:99], v[156:159]
    ds_read_b64_tr_b16 v[20:21], v11 offset:16384
    v_mfma_f32_16x16x32_bf16 v[160:163], v[64:67], v[100:103], v[160:163]
    ds_read_b64_tr_b16 v[22:23], v11 offset:17408
    v_mfma_f32_16x16x32_bf16 v[168:171], v[80:83], v[100:103], v[168:171]
    ds_read_b64_tr_b16 v[36:37], v11 offset:32768
    v_mfma_f32_16x16x32_bf16 v[164:167], v[68:71], v[100:103], v[164:167]
    ds_read_b64_tr_b16 v[38:39], v11 offset:33792
    v_mfma_f32_16x16x32_bf16 v[172:175], v[84:87], v[100:103], v[172:175]
    ds_read_b128 v[56:59], v14 offset:4096
    v_mfma_f32_16x16x32_bf16 v[176:179], v[72:75], v[100:103], v[176:179]
    ds_read_b64_tr_b16 v[24:25], v12 offset:16384
    v_mfma_f32_16x16x32_bf16 v[184:187], v[88:91], v[100:103], v[184:187]
    ds_read_b64_tr_b16 v[26:27], v12 offset:17408
    v_mfma_f32_16x16x32_bf16 v[180:183], v[76:79], v[100:103], v[180:183]
    ds_read_b64_tr_b16 v[40:41], v12 offset:32768
    v_mfma_f32_16x16x32_bf16 v[188:191], v[92:95], v[100:103], v[188:191]
    ds_read_b64_tr_b16 v[42:43], v12 offset:33792
    v_mfma_f32_16x16x32_bf16 v[192:195], v[64:67], v[104:107], v[192:195]
    ds_read_b128 v[60:63], v14 offset:6144
    v_mfma_f32_16x16x32_bf16 v[200:203], v[80:83], v[104:107], v[200:203]
    ds_read_b64_tr_b16 v[28:29], v13 offset:16384
    v_mfma_f32_16x16x32_bf16 v[196:199], v[68:71], v[104:107], v[196:199]
    ds_read_b64_tr_b16 v[30:31], v13 offset:17408
    v_mfma_f32_16x16x32_bf16 v[204:207], v[84:87], v[104:107], v[204:207]
    ds_read_b64_tr_b16 v[44:45], v13 offset:32768
    v_mfma_f32_16x16x32_bf16 v[208:211], v[72:75], v[104:107], v[208:211]
    ds_read_b64_tr_b16 v[46:47], v13 offset:33792
    v_mfma_f32_16x16x32_bf16 v[216:219], v[88:91], v[104:107], v[216:219]
    v_mfma_f32_16x16x32_bf16 v[212:215], v[76:79], v[104:107], v[212:215]
    v_mfma_f32_16x16x32_bf16 v[220:223], v[92:95], v[104:107], v[220:223]
    v_mfma_f32_16x16x32_bf16 v[224:227], v[64:67], v[108:111], v[224:227]
    v_mfma_f32_16x16x32_bf16 v[232:235], v[80:83], v[108:111], v[232:235]
    v_mfma_f32_16x16x32_bf16 v[228:231], v[68:71], v[108:111], v[228:231]
    v_mfma_f32_16x16x32_bf16 v[236:239], v[84:87], v[108:111], v[236:239]
    v_mfma_f32_16x16x32_bf16 v[240:243], v[72:75], v[108:111], v[240:243]
    v_mfma_f32_16x16x32_bf16 v[248:251], v[88:91], v[108:111], v[248:251]
    v_mfma_f32_16x16x32_bf16 v[244:247], v[76:79], v[108:111], v[244:247]
    v_mfma_f32_16x16x32_bf16 v[252:255], v[92:95], v[108:111], v[252:255]
    s_waitcnt lgkmcnt(0)
    v_mfma_f32_16x16x32_bf16 v[128:131], v[16:19], v[48:51], v[128:131]
    ds_read_b128 v[96:99], v15 offset:0
    v_mfma_f32_16x16x32_bf16 v[136:139], v[32:35], v[48:51], v[136:139]
    ds_read_b64_tr_b16 v[64:65], v10 offset:24576
    v_mfma_f32_16x16x32_bf16 v[132:135], v[20:23], v[48:51], v[132:135]
    ds_read_b64_tr_b16 v[66:67], v10 offset:25600
    v_mfma_f32_16x16x32_bf16 v[140:143], v[36:39], v[48:51], v[140:143]
    ds_read_b64_tr_b16 v[80:81], v10 offset:40960
    v_mfma_f32_16x16x32_bf16 v[144:147], v[24:27], v[48:51], v[144:147]
    ds_read_b64_tr_b16 v[82:83], v10 offset:41984
    v_mfma_f32_16x16x32_bf16 v[152:155], v[40:43], v[48:51], v[152:155]
    ds_read_b128 v[100:103], v15 offset:2048
    v_mfma_f32_16x16x32_bf16 v[148:151], v[28:31], v[48:51], v[148:151]
    ds_read_b64_tr_b16 v[68:69], v11 offset:24576
    v_mfma_f32_16x16x32_bf16 v[156:159], v[44:47], v[48:51], v[156:159]
    ds_read_b64_tr_b16 v[70:71], v11 offset:25600
    v_mfma_f32_16x16x32_bf16 v[160:163], v[16:19], v[52:55], v[160:163]
    ds_read_b64_tr_b16 v[84:85], v11 offset:40960
    v_mfma_f32_16x16x32_bf16 v[168:171], v[32:35], v[52:55], v[168:171]
    ds_read_b64_tr_b16 v[86:87], v11 offset:41984
    v_mfma_f32_16x16x32_bf16 v[164:167], v[20:23], v[52:55], v[164:167]
    ds_read_b128 v[104:107], v15 offset:4096
    v_mfma_f32_16x16x32_bf16 v[172:175], v[36:39], v[52:55], v[172:175]
    ds_read_b64_tr_b16 v[72:73], v12 offset:24576
    v_mfma_f32_16x16x32_bf16 v[176:179], v[24:27], v[52:55], v[176:179]
    ds_read_b64_tr_b16 v[74:75], v12 offset:25600
    v_mfma_f32_16x16x32_bf16 v[184:187], v[40:43], v[52:55], v[184:187]
    ds_read_b64_tr_b16 v[88:89], v12 offset:40960
    v_mfma_f32_16x16x32_bf16 v[180:183], v[28:31], v[52:55], v[180:183]
    ds_read_b64_tr_b16 v[90:91], v12 offset:41984
    v_mfma_f32_16x16x32_bf16 v[188:191], v[44:47], v[52:55], v[188:191]
    ds_read_b128 v[108:111], v15 offset:6144
    v_mfma_f32_16x16x32_bf16 v[192:195], v[16:19], v[56:59], v[192:195]
    ds_read_b64_tr_b16 v[76:77], v13 offset:24576
    v_mfma_f32_16x16x32_bf16 v[200:203], v[32:35], v[56:59], v[200:203]
    ds_read_b64_tr_b16 v[78:79], v13 offset:25600
    v_mfma_f32_16x16x32_bf16 v[196:199], v[20:23], v[56:59], v[196:199]
    ds_read_b64_tr_b16 v[92:93], v13 offset:40960
    v_mfma_f32_16x16x32_bf16 v[204:207], v[36:39], v[56:59], v[204:207]
    ds_read_b64_tr_b16 v[94:95], v13 offset:41984
    v_mfma_f32_16x16x32_bf16 v[208:211], v[24:27], v[56:59], v[208:211]
    ds_read_b128 v[116:119], v112 offset:80
    v_mfma_f32_16x16x32_bf16 v[216:219], v[40:43], v[56:59], v[216:219]
    v_mfma_f32_16x16x32_bf16 v[212:215], v[28:31], v[56:59], v[212:215]
    v_mfma_f32_16x16x32_bf16 v[220:223], v[44:47], v[56:59], v[220:223]
    v_mfma_f32_16x16x32_bf16 v[224:227], v[16:19], v[60:63], v[224:227]
    v_mfma_f32_16x16x32_bf16 v[232:235], v[32:35], v[60:63], v[232:235]
    s_add_u32 s90, s90, 1
    s_cmp_eq_u32 s90, 3
    v_mfma_f32_16x16x32_bf16 v[228:231], v[20:23], v[60:63], v[228:231]
    s_cselect_b32 s88, s92, s93
    s_cselect_b32 s90, 0, s90
    v_mfma_f32_16x16x32_bf16 v[236:239], v[36:39], v[60:63], v[236:239]
    s_add_u32 s89, s89, 1
    v_add_u32 v10, s88, v10
    v_mfma_f32_16x16x32_bf16 v[240:243], v[24:27], v[60:63], v[240:243]
    v_add_u32 v11, s88, v11
    v_add_u32 v12, s88, v12
    v_mfma_f32_16x16x32_bf16 v[248:251], v[40:43], v[60:63], v[248:251]
    v_add_u32 v13, s88, v13
    v_add_u32 v14, s88, v14
    v_mfma_f32_16x16x32_bf16 v[244:247], v[28:31], v[60:63], v[244:247]
    v_add_u32 v15, s88, v15
    v_mfma_f32_16x16x32_bf16 v[252:255], v[44:47], v[60:63], v[252:255]
L_cg1_in:
    s_waitcnt lgkmcnt(0)
    v_mfma_f32_16x16x32_bf16 v[128:131], v[64:67], v[96:99], v[128:131]
    s_cmp_gt_u32 s89, 6
    s_cbranch_scc1 L_fl0
    s_barrier
    s_branch L_cg1
L_fl0:
    v_mov_b32 v113, s89
    s_cmp_lt_u32 s89, 8
    ds_write_b32 v114, v113
    v_min3_u32 v116, v116, v117, v118
    v_min_u32 v116, v116, v119
    v_cmp_le_u32 vcc, s89, v116
    s_cbranch_vccnz L_af0
    v_mov_b32 v115, 163024
L_qagain_16:
    ds_read_b128 v[116:119], v115
    s_waitcnt lgkmcnt(0)
    v_min3_u32 v116, v116, v117, v118
    v_min_u32 v116, v116, v119
    v_cmp_le_u32 vcc, s89, v116
    s_cbranch_vccnz L_qok_15
    s_sleep 1
    s_branch L_qagain_16
L_qok_15:
L_af0:
    s_cbranch_scc1 L_cg1
    v_mfma_f32_16x16x32_bf16 v[136:139], v[80:83], v[96:99], v[136:139]
    ds_read_b64 v[48:49], v4 offset:0
    v_mfma_f32_16x16x32_bf16 v[132:135], v[68:71], v[96:99], v[132:135]
    ds_read_b64 v[50:51], v4 offset:128
    v_mfma_f32_16x16x32_bf16 v[140:143], v[84:87], v[96:99], v[140:143]
    ds_read_b64 v[52:53], v4 offset:256
    v_mfma_f32_16x16x32_bf16 v[144:147], v[72:75], v[96:99], v[144:147]
    ds_read_b64 v[54:55], v4 offset:384
    v_mfma_f32_16x16x32_bf16 v[152:155], v[88:91], v[96:99], v[152:155]
    ds_read_b64 v[56:57], v112
    v_mfma_f32_16x16x32_bf16 v[148:151], v[76:79], v[96:99], v[148:151]
    ds_read_b128 v[16:19], v5 offset:0
    v_mfma_f32_16x16x32_bf16 v[156:159], v[92:95], v[96:99], v[156:159]
    ds_read_b128 v[20:23], v5 offset:64
    v_mfma_f32_16x16x32_bf16 v[160:163], v[64:67], v[100:103], v[160:163]
    ds_read_b128 v[24:27], v5 offset:512
    v_mfma_f32_16x16x32_bf16 v[168:171], v[80:83], v[100:103], v[168:171]
    ds_read_b128 v[28:31], v5 offset:576
    v_mfma_f32_16x16x32_bf16 v[164:167], v[68:71], v[100:103], v[164:167]
    ds_read_b128 v[32:35], v5 offset:128
    v_mfma_f32_16x16x32_bf16 v[172:175], v[84:87], v[100:103], v[172:175]
    ds_read_b128 v[36:39], v5 offset:192
    v_mfma_f32_16x16x32_bf16 v[176:179], v[72:75], v[100:103], v[176:179]
    ds_read_b128 v[40:43], v5 offset:640
    v_mfma_f32_16x16x32_bf16 v[184:187], v[88:91], v[100:103], v[184:187]
    ds_read_b128 v[44:47], v5 offset:704
    v_mfma_f32_16x16x32_bf16 v[180:183], v[76:79], v[100:103], v[180:183]
    v_mfma_f32_16x16x32_bf16 v[188:191], v[92:95], v[100:103], v[188:191]
    v_mfma_f32_16x16x32_bf16 v[192:195], v[64:67], v[104:107], v[192:195]
    v_mfma_f32_16x16x32_bf16 v[200:203], v[80:83], v[104:107], v[200:203]
    v_mfma_f32_16x16x32_bf16 v[196:199], v[68:71], v[104:107], v[196:199]
    v_mfma_f32_16x16x32_bf16 v[204:207], v[84:87], v[104:107], v[204:207]
    v_mfma_f32_16x16x32_bf16 v[208:211], v[72:75], v[104:107], v[208:211]
    v_mfma_f32_16x16x32_bf16 v[216:219], v[88:91], v[104:107], v[216:219]
    v_mfma_f32_16x16x32_bf16 v[212:215], v[76:79], v[104:107], v[212:215]
    v_mfma_f32_16x16x32_bf16 v[220:223], v[92:95], v[104:107], v[220:223]
    v_mfma_f32_16x16x32_bf16 v[224:227], v[64:67], v[108:111], v[224:227]
    v_mfma_f32_16x16x32_bf16 v[232:235], v[80:83], v[108:111], v[232:235]
    v_mfma_f32_16x16x32_bf16 v[228:231], v[68:71], v[108:111], v[228:231]
    v_mfma_f32_16x16x32_bf16 v[236:239], v[84:87], v[108:111], v[236:239]
    v_mfma_f32_16x16x32_bf16 v[240:243], v[72:75], v[108:111], v[240:243]
    v_mfma_f32_16x16x32_bf16 v[248:251], v[88:91], v[108:111], v[248:251]
    v_mfma_f32_16x16x32_bf16 v[244:247], v[76:79], v[108:111], v[244:247]
    v_mfma_f32_16x16x32_bf16 v[252:255], v[92:95], v[108:111], v[252:255]
    s_waitcnt lgkmcnt(0)
    v_mul_f32 v58, 0xbfb8aa3b, v49
    v_mul_f32 v60, 0xbfb8aa3b, v51
    v_mul_f32 v62, 0xbfb8aa3b, v53
    v_mul_f32 v64, 0xbfb8aa3b, v55
    v_readfirstlane_b32 s82, v56
    v_readfirstlane_b32 s83, v57
    v_pk_fma_f32 v[128:129], v[16:17], v[48:49], v[128:129] op_sel_hi:[1,0,1] neg_lo:[0,1,0] neg_hi:[0,1,0]
    v_pk_fma_f32 v[130:131], v[18:19], v[48:49], v[130:131] op_sel_hi:[1,0,1] neg_lo:[0,1,0] neg_hi:[0,1,0]
    v_pk_fma_f32 v[132:133], v[20:21], v[48:49], v[132:133] op_sel_hi:[1,0,1] neg_lo:[0,1,0] neg_hi:[0,1,0]
    v_pk_fma_f32 v[134:135], v[22:23], v[48:49], v[134:135] op_sel_hi:[1,0,1] neg_lo:[0,1,0] neg_hi:[0,1,0]
    v_pk_mul_f32 v[128:129], v[128:129], v[58:59] op_sel_hi:[1,0]
    v_pk_mul_f32 v[130:131], v[130:131], v[58:59] op_sel_hi:[1,0]
    v_pk_mul_f32 v[132:133], v[132:133], v[58:59] op_sel_hi:[1,0]
    v_pk_mul_f32 v[134:135], v[134:135], v[58:59] op_sel_hi:[1,0]
    v_exp_f32 v66, v128
    v_exp_f32 v67, v129
    v_pk_fma_f32 v[136:137], v[24:25], v[48:49], v[136:137] op_sel_hi:[1,0,1] neg_lo:[0,1,0] neg_hi:[0,1,0]
    v_exp_f32 v68, v130
    v_exp_f32 v69, v131
    v_pk_fma_f32 v[138:139], v[26:27], v[48:49], v[138:139] op_sel_hi:[1,0,1] neg_lo:[0,1,0] neg_hi:[0,1,0]
    v_exp_f32 v70, v132
    v_exp_f32 v71, v133
    v_pk_fma_f32 v[140:141], v[28:29], v[48:49], v[140:141] op_sel_hi:[1,0,1] neg_lo:[0,1,0] neg_hi:[0,1,0]
    v_exp_f32 v72, v134
    v_exp_f32 v73, v135
    v_pk_fma_f32 v[142:143], v[30:31], v[48:49], v[142:143] op_sel_hi:[1,0,1] neg_lo:[0,1,0] neg_hi:[0,1,0]
    v_pk_add_f32 v[66:67], v[66:67], 1.0 op_sel_hi:[1,0]
    v_pk_add_f32 v[68:69], v[68:69], 1.0 op_sel_hi:[1,0]
    v_pk_add_f32 v[70:71], v[70:71], 1.0 op_sel_hi:[1,0]
    v_pk_add_f32 v[72:73], v[72:73], 1.0 op_sel_hi:[1,0]
    v_rcp_f32 v66, v66
    v_rcp_f32 v67, v67
    v_pk_mul_f32 v[128:129], v[128:129], v[136:137]
    v_rcp_f32 v68, v68
    v_rcp_f32 v69, v69
    v_pk_mul_f32 v[130:131], v[130:131], v[138:139]
    v_rcp_f32 v70, v70
    v_rcp_f32 v71, v71
    v_pk_mul_f32 v[132:133], v[132:133], v[140:141]
    v_rcp_f32 v72, v72
    v_rcp_f32 v73, v73
    v_pk_mul_f32 v[134:135], v[134:135], v[142:143]
    v_pk_mul_f32 v[128:129], v[128:129], v[66:67]
    v_pk_mul_f32 v[130:131], v[130:131], v[68:69]
    v_pk_mul_f32 v[132:133], v[132:133], v[70:71]
    v_pk_mul_f32 v[134:135], v[134:135], v[72:73]
    v_cvt_pk_bf16_f32 v84, v128, v129
    v_cvt_pk_bf16_f32 v85, v130, v131
    v_cvt_pk_bf16_f32 v86, v132, v133
    v_cvt_pk_bf16_f32 v87, v134, v135
    buffer_store_dwordx4 v[84:87], v6, s[40:43], s52 offen offset:0 sc1
    v_pk_fma_f32 v[160:161], v[16:17], v[50:51], v[160:161] op_sel_hi:[1,0,1] neg_lo:[0,1,0] neg_hi:[0,1,0]
    v_pk_fma_f32 v[162:163], v[18:19], v[50:51], v[162:163] op_sel_hi:[1,0,1] neg_lo:[0,1,0] neg_hi:[0,1,0]
    v_pk_fma_f32 v[164:165], v[20:21], v[50:51], v[164:165] op_sel_hi:[1,0,1] neg_lo:[0,1,0] neg_hi:[0,1,0]
    v_pk_fma_f32 v[166:167], v[22:23], v[50:51], v[166:167] op_sel_hi:[1,0,1] neg_lo:[0,1,0] neg_hi:[0,1,0]
    v_pk_mul_f32 v[160:161], v[160:161], v[60:61] op_sel_hi:[1,0]
    v_pk_mul_f32 v[162:163], v[162:163], v[60:61] op_sel_hi:[1,0]
    v_pk_mul_f32 v[164:165], v[164:165], v[60:61] op_sel_hi:[1,0]
    v_pk_mul_f32 v[166:167], v[166:167], v[60:61] op_sel_hi:[1,0]
    v_exp_f32 v74, v160
    v_exp_f32 v75, v161
    v_pk_fma_f32 v[168:169], v[24:25], v[50:51], v[168:169] op_sel_hi:[1,0,1] neg_lo:[0,1,0] neg_hi:[0,1,0]
    v_exp_f32 v76, v162
    v_exp_f32 v77, v163
    v_pk_fma_f32 v[170:171], v[26:27], v[50:51], v[170:171] op_sel_hi:[1,0,1] neg_lo:[0,1,0] neg_hi:[0,1,0]
    v_exp_f32 v78, v164
    v_exp_f32 v79, v165
    v_pk_fma_f32 v[172:173], v[28:29], v[50:51], v[172:173] op_sel_hi:[1,0,1] neg_lo:[0,1,0] neg_hi:[0,1,0]
    v_exp_f32 v80, v166
    v_exp_f32 v81, v167
    v_pk_fma_f32 v[174:175], v[30:31], v[50:51], v[174:175] op_sel_hi:[1,0,1] neg_lo:[0,1,0] neg_hi:[0,1,0]
    v_pk_add_f32 v[74:75], v[74:75], 1.0 op_sel_hi:[1,0]
    v_pk_add_f32 v[76:77], v[76:77], 1.0 op_sel_hi:[1,0]
    v_pk_add_f32 v[78:79], v[78:79], 1.0 op_sel_hi:[1,0]
    v_pk_add_f32 v[80:81], v[80:81], 1.0 op_sel_hi:[1,0]
    v_rcp_f32 v74, v74
    v_rcp_f32 v75, v75
    v_pk_mul_f32 v[160:161], v[160:161], v[168:169]
    v_rcp_f32 v76, v76
    v_rcp_f32 v77, v77
    v_pk_mul_f32 v[162:163], v[162:163], v[170:171]
    v_rcp_f32 v78, v78
    v_rcp_f32 v79, v79
    v_pk_mul_f32 v[164:165], v[164:165], v[172:173]
    v_rcp_f32 v80, v80
    v_rcp_f32 v81, v81
    v_pk_mul_f32 v[166:167], v[166:167], v[174:175]
    v_pk_mul_f32 v[160:161], v[160:161], v[74:75]
    v_pk_mul_f32 v[162:163], v[162:163], v[76:77]
    v_pk_mul_f32 v[164:165], v[164:165], v[78:79]
    v_pk_mul_f32 v[166:167], v[166:167], v[80:81]
    v_cvt_pk_bf16_f32 v88, v160, v161
    v_cvt_pk_bf16_f32 v89, v162, v163
    v_cvt_pk_bf16_f32 v90, v164, v165
    v_cvt_pk_bf16_f32 v91, v166, v167
    buffer_store_dwordx4 v[88:91], v6, s[40:43], s53 offen offset:0 sc1
    v_pk_fma_f32 v[192:193], v[16:17], v[52:53], v[192:193] op_sel_hi:[1,0,1] neg_lo:[0,1,0] neg_hi:[0,1,0]
    v_pk_fma_f32 v[194:195], v[18:19], v[52:53], v[194:195] op_sel_hi:[1,0,1] neg_lo:[0,1,0] neg_hi:[0,1,0]
    v_pk_fma_f32 v[196:197], v[20:21], v[52:53], v[196:197] op_sel_hi:[1,0,1] neg_lo:[0,1,0] neg_hi:[0,1,0]
    v_pk_fma_f32 v[198:199], v[22:23], v[52:53], v[198:199] op_sel_hi:[1,0,1] neg_lo:[0,1,0] neg_hi:[0,1,0]
    v_pk_mul_f32 v[192:193], v[192:193], v[62:63] op_sel_hi:[1,0]
    v_pk_mul_f32 v[194:195], v[194:195], v[62:63] op_sel_hi:[1,0]
    v_pk_mul_f32 v[196:197], v[196:197], v[62:63] op_sel_hi:[1,0]
    v_pk_mul_f32 v[198:199], v[198:199], v[62:63] op_sel_hi:[1,0]
    v_exp_f32 v66, v192
    v_exp_f32 v67, v193
    v_pk_fma_f32 v[200:201], v[24:25], v[52:53], v[200:201] op_sel_hi:[1,0,1] neg_lo:[0,1,0] neg_hi:[0,1,0]
    v_exp_f32 v68, v194
    v_exp_f32 v69, v195
    v_pk_fma_f32 v[202:203], v[26:27], v[52:53], v[202:203] op_sel_hi:[1,0,1] neg_lo:[0,1,0] neg_hi:[0,1,0]
    v_exp_f32 v70, v196
    v_exp_f32 v71, v197
    v_pk_fma_f32 v[204:205], v[28:29], v[52:53], v[204:205] op_sel_hi:[1,0,1] neg_lo:[0,1,0] neg_hi:[0,1,0]
    v_exp_f32 v72, v198
    v_exp_f32 v73, v199
    v_pk_fma_f32 v[206:207], v[30:31], v[52:53], v[206:207] op_sel_hi:[1,0,1] neg_lo:[0,1,0] neg_hi:[0,1,0]
    v_pk_add_f32 v[66:67], v[66:67], 1.0 op_sel_hi:[1,0]
    v_pk_add_f32 v[68:69], v[68:69], 1.0 op_sel_hi:[1,0]
    v_pk_add_f32 v[70:71], v[70:71], 1.0 op_sel_hi:[1,0]
    v_pk_add_f32 v[72:73], v[72:73], 1.0 op_sel_hi:[1,0]
    v_rcp_f32 v66, v66
    v_rcp_f32 v67, v67
    v_pk_mul_f32 v[192:193], v[192:193], v[200:201]
    v_rcp_f32 v68, v68
    v_rcp_f32 v69, v69
    v_pk_mul_f32 v[194:195], v[194:195], v[202:203]
    v_rcp_f32 v70, v70
    v_rcp_f32 v71, v71
    v_pk_mul_f32 v[196:197], v[196:197], v[204:205]
    v_rcp_f32 v72, v72
    v_rcp_f32 v73, v73
    v_pk_mul_f32 v[198:199], v[198:199], v[206:207]
    v_pk_mul_f32 v[192:193], v[192:193], v[66:67]
    v_pk_mul_f32 v[194:195], v[194:195], v[68:69]
    v_pk_mul_f32 v[196:197], v[196:197], v[70:71]
    v_pk_mul_f32 v[198:199], v[198:199], v[72:73]
    v_cvt_pk_bf16_f32 v92, v192, v193
    v_cvt_pk_bf16_f32 v93, v194, v195
    v_cvt_pk_bf16_f32 v94, v196, v197
    v_cvt_pk_bf16_f32 v95, v198, v199
    buffer_store_dwordx4 v[92:95], v6, s[40:43], s54 offen offset:0 sc1
    v_pk_fma_f32 v[224:225], v[16:17], v[54:55], v[224:225] op_sel_hi:[1,0,1] neg_lo:[0,1,0] neg_hi:[0,1,0]
    v_pk_fma_f32 v[226:227], v[18:19], v[54:55], v[226:227] op_sel_hi:[1,0,1] neg_lo:[0,1,0] neg_hi:[0,1,0]
    v_pk_fma_f32 v[228:229], v[20:21], v[54:55], v[228:229] op_sel_hi:[1,0,1] neg_lo:[0,1,0] neg_hi:[0,1,0]
    v_pk_fma_f32 v[230:231], v[22:23], v[54:55], v[230:231] op_sel_hi:[1,0,1] neg_lo:[0,1,0] neg_hi:[0,1,0]
    v_pk_mul_f32 v[224:225], v[224:225], v[64:65] op_sel_hi:[1,0]
    v_pk_mul_f32 v[226:227], v[226:227], v[64:65] op_sel_hi:[1,0]
    v_pk_mul_f32 v[228:229], v[228:229], v[64:65] op_sel_hi:[1,0]
    v_pk_mul_f32 v[230:231], v[230:231], v[64:65] op_sel_hi:[1,0]
    v_exp_f32 v74, v224
    v_exp_f32 v75, v225
    v_pk_fma_f32 v[232:233], v[24:25], v[54:55], v[232:233] op_sel_hi:[1,0,1] neg_lo:[0,1,0] neg_hi:[0,1,0]
    v_exp_f32 v76, v226
    v_exp_f32 v77, v227
    v_pk_fma_f32 v[234:235], v[26:27], v[54:55], v[234:235] op_sel_hi:[1,0,1] neg_lo:[0,1,0] neg_hi:[0,1,0]
    v_exp_f32 v78, v228
    v_exp_f32 v79, v229
    v_pk_fma_f32 v[236:237], v[28:29], v[54:55], v[236:237] op_sel_hi:[1,0,1] neg_lo:[0,1,0] neg_hi:[0,1,0]
    v_exp_f32 v80, v230
    v_exp_f32 v81, v231
    v_pk_fma_f32 v[238:239], v[30:31], v[54:55], v[238:239] op_sel_hi:[1,0,1] neg_lo:[0,1,0] neg_hi:[0,1,0]
    v_pk_add_f32 v[74:75], v[74:75], 1.0 op_sel_hi:[1,0]
    v_pk_add_f32 v[76:77], v[76:77], 1.0 op_sel_hi:[1,0]
    v_pk_add_f32 v[78:79], v[78:79], 1.0 op_sel_hi:[1,0]
    v_pk_add_f32 v[80:81], v[80:81], 1.0 op_sel_hi:[1,0]
    v_rcp_f32 v74, v74
    v_rcp_f32 v75, v75
    v_pk_mul_f32 v[224:225], v[224:225], v[232:233]
    v_rcp_f32 v76, v76
    v_rcp_f32 v77, v77
    v_pk_mul_f32 v[226:227], v[226:227], v[234:235]
    v_rcp_f32 v78, v78
    v_rcp_f32 v79, v79
    v_pk_mul_f32 v[228:229], v[228:229], v[236:237]
    v_rcp_f32 v80, v80
    v_rcp_f32 v81, v81
    v_pk_mul_f32 v[230:231], v[230:231], v[238:239]
    v_pk_mul_f32 v[224:225], v[224:225], v[74:75]
    v_pk_mul_f32 v[226:227], v[226:227], v[76:77]
    v_pk_mul_f32 v[228:229], v[228:229], v[78:79]
    v_pk_mul_f32 v[230:231], v[230:231], v[80:81]
    v_cvt_pk_bf16_f32 v84, v224, v225
    v_cvt_pk_bf16_f32 v85, v226, v227
    v_cvt_pk_bf16_f32 v86, v228, v229
    v_cvt_pk_bf16_f32 v87, v230, v231
    buffer_store_dwordx4 v[84:87], v6, s[40:43], s55 offen offset:0 sc1
    v_pk_fma_f32 v[144:145], v[32:33], v[48:49], v[144:145] op_sel_hi:[1,0,1] neg_lo:[0,1,0] neg_hi:[0,1,0]
    v_pk_fma_f32 v[146:147], v[34:35], v[48:49], v[146:147] op_sel_hi:[1,0,1] neg_lo:[0,1,0] neg_hi:[0,1,0]
    v_pk_fma_f32 v[148:149], v[36:37], v[48:49], v[148:149] op_sel_hi:[1,0,1] neg_lo:[0,1,0] neg_hi:[0,1,0]
    v_pk_fma_f32 v[150:151], v[38:39], v[48:49], v[150:151] op_sel_hi:[1,0,1] neg_lo:[0,1,0] neg_hi:[0,1,0]
    v_pk_mul_f32 v[144:145], v[144:145], v[58:59] op_sel_hi:[1,0]
    v_pk_mul_f32 v[146:147], v[146:147], v[58:59] op_sel_hi:[1,0]
    v_pk_mul_f32 v[148:149], v[148:149], v[58:59] op_sel_hi:[1,0]
    v_pk_mul_f32 v[150:151], v[150:151], v[58:59] op_sel_hi:[1,0]
    v_exp_f32 v66, v144
    v_exp_f32 v67, v145
    v_pk_fma_f32 v[152:153], v[40:41], v[48:49], v[152:153] op_sel_hi:[1,0,1] neg_lo:[0,1,0] neg_hi:[0,1,0]
    v_exp_f32 v68, v146
    v_exp_f32 v69, v147
    v_pk_fma_f32 v[154:155], v[42:43], v[48:49], v[154:155] op_sel_hi:[1,0,1] neg_lo:[0,1,0] neg_hi:[0,1,0]
    v_exp_f32 v70, v148
    v_exp_f32 v71, v149
    v_pk_fma_f32 v[156:157], v[44:45], v[48:49], v[156:157] op_sel_hi:[1,0,1] neg_lo:[0,1,0] neg_hi:[0,1,0]
    v_exp_f32 v72, v150
    v_exp_f32 v73, v151
    v_pk_fma_f32 v[158:159], v[46:47], v[48:49], v[158:159] op_sel_hi:[1,0,1] neg_lo:[0,1,0] neg_hi:[0,1,0]
    v_pk_add_f32 v[66:67], v[66:67], 1.0 op_sel_hi:[1,0]
    v_pk_add_f32 v[68:69], v[68:69], 1.0 op_sel_hi:[1,0]
    v_pk_add_f32 v[70:71], v[70:71], 1.0 op_sel_hi:[1,0]
    v_pk_add_f32 v[72:73], v[72:73], 1.0 op_sel_hi:[1,0]
    v_rcp_f32 v66, v66
    v_rcp_f32 v67, v67
    v_pk_mul_f32 v[144:145], v[144:145], v[152:153]
    v_rcp_f32 v68, v68
    v_rcp_f32 v69, v69
    v_pk_mul_f32 v[146:147], v[146:147], v[154:155]
    v_rcp_f32 v70, v70
    v_rcp_f32 v71, v71
    v_pk_mul_f32 v[148:149], v[148:149], v[156:157]
    v_rcp_f32 v72, v72
    v_rcp_f32 v73, v73
    v_pk_mul_f32 v[150:151], v[150:151], v[158:159]
    v_pk_mul_f32 v[144:145], v[144:145], v[66:67]
    v_pk_mul_f32 v[146:147], v[146:147], v[68:69]
    v_pk_mul_f32 v[148:149], v[148:149], v[70:71]
    v_pk_mul_f32 v[150:151], v[150:151], v[72:73]
    v_cvt_pk_bf16_f32 v88, v144, v145
    v_cvt_pk_bf16_f32 v89, v146, v147
    v_cvt_pk_bf16_f32 v90, v148, v149
    v_cvt_pk_bf16_f32 v91, v150, v151
    buffer_store_dwordx4 v[88:91], v6, s[40:43], s52 offen offset:1024 sc1
    v_pk_fma_f32 v[176:177], v[32:33], v[50:51], v[176:177] op_sel_hi:[1,0,1] neg_lo:[0,1,0] neg_hi:[0,1,0]
    v_pk_fma_f32 v[178:179], v[34:35], v[50:51], v[178:179] op_sel_hi:[1,0,1] neg_lo:[0,1,0] neg_hi:[0,1,0]
    v_pk_fma_f32 v[180:181], v[36:37], v[50:51], v[180:181] op_sel_hi:[1,0,1] neg_lo:[0,1,0] neg_hi:[0,1,0]
    v_pk_fma_f32 v[182:183], v[38:39], v[50:51], v[182:183] op_sel_hi:[1,0,1] neg_lo:[0,1,0] neg_hi:[0,1,0]
    v_pk_mul_f32 v[176:177], v[176:177], v[60:61] op_sel_hi:[1,0]
    v_pk_mul_f32 v[178:179], v[178:179], v[60:61] op_sel_hi:[1,0]
    v_pk_mul_f32 v[180:181], v[180:181], v[60:61] op_sel_hi:[1,0]
    v_pk_mul_f32 v[182:183], v[182:183], v[60:61] op_sel_hi:[1,0]
    v_exp_f32 v74, v176
    v_exp_f32 v75, v177
    v_pk_fma_f32 v[184:185], v[40:41], v[50:51], v[184:185] op_sel_hi:[1,0,1] neg_lo:[0,1,0] neg_hi:[0,1,0]
    v_exp_f32 v76, v178
    v_exp_f32 v77, v179
    v_pk_fma_f32 v[186:187], v[42:43], v[50:51], v[186:187] op_sel_hi:[1,0,1] neg_lo:[0,1,0] neg_hi:[0,1,0]
    v_exp_f32 v78, v180
    v_exp_f32 v79, v181
    v_pk_fma_f32 v[188:189], v[44:45], v[50:51], v[188:189] op_sel_hi:[1,0,1] neg_lo:[0,1,0] neg_hi:[0,1,0]
    v_exp_f32 v80, v182
    v_exp_f32 v81, v183
    v_pk_fma_f32 v[190:191], v[46:47], v[50:51], v[190:191] op_sel_hi:[1,0,1] neg_lo:[0,1,0] neg_hi:[0,1,0]
    v_pk_add_f32 v[74:75], v[74:75], 1.0 op_sel_hi:[1,0]
    v_pk_add_f32 v[76:77], v[76:77], 1.0 op_sel_hi:[1,0]
    v_pk_add_f32 v[78:79], v[78:79], 1.0 op_sel_hi:[1,0]
    v_pk_add_f32 v[80:81], v[80:81], 1.0 op_sel_hi:[1,0]
    v_rcp_f32 v74, v74
    v_rcp_f32 v75, v75
    v_pk_mul_f32 v[176:177], v[176:177], v[184:185]
    v_rcp_f32 v76, v76
    v_rcp_f32 v77, v77
    v_pk_mul_f32 v[178:179], v[178:179], v[186:187]
    v_rcp_f32 v78, v78
    v_rcp_f32 v79, v79
    v_pk_mul_f32 v[180:181], v[180:181], v[188:189]
    v_rcp_f32 v80, v80
    v_rcp_f32 v81, v81
    v_pk_mul_f32 v[182:183], v[182:183], v[190:191]
    v_pk_mul_f32 v[176:177], v[176:177], v[74:75]
    v_pk_mul_f32 v[178:179], v[178:179], v[76:77]
    v_pk_mul_f32 v[180:181], v[180:181], v[78:79]
    v_pk_mul_f32 v[182:183], v[182:183], v[80:81]
    v_cvt_pk_bf16_f32 v92, v176, v177
    v_cvt_pk_bf16_f32 v93, v178, v179
    v_cvt_pk_bf16_f32 v94, v180, v181
    v_cvt_pk_bf16_f32 v95, v182, v183
    buffer_store_dwordx4 v[92:95], v6, s[40:43], s53 offen offset:1024 sc1
    v_pk_fma_f32 v[208:209], v[32:33], v[52:53], v[208:209] op_sel_hi:[1,0,1] neg_lo:[0,1,0] neg_hi:[0,1,0]
    v_pk_fma_f32 v[210:211], v[34:35], v[52:53], v[210:211] op_sel_hi:[1,0,1] neg_lo:[0,1,0] neg_hi:[0,1,0]
    v_pk_fma_f32 v[212:213], v[36:37], v[52:53], v[212:213] op_sel_hi:[1,0,1] neg_lo:[0,1,0] neg_hi:[0,1,0]
    v_pk_fma_f32 v[214:215], v[38:39], v[52:53], v[214:215] op_sel_hi:[1,0,1] neg_lo:[0,1,0] neg_hi:[0,1,0]
    v_pk_mul_f32 v[208:209], v[208:209], v[62:63] op_sel_hi:[1,0]
    v_pk_mul_f32 v[210:211], v[210:211], v[62:63] op_sel_hi:[1,0]
    v_pk_mul_f32 v[212:213], v[212:213], v[62:63] op_sel_hi:[1,0]
    v_pk_mul_f32 v[214:215], v[214:215], v[62:63] op_sel_hi:[1,0]
    v_exp_f32 v66, v208
    v_exp_f32 v67, v209
    v_pk_fma_f32 v[216:217], v[40:41], v[52:53], v[216:217] op_sel_hi:[1,0,1] neg_lo:[0,1,0] neg_hi:[0,1,0]
    v_exp_f32 v68, v210
    v_exp_f32 v69, v211
    v_pk_fma_f32 v[218:219], v[42:43], v[52:53], v[218:219] op_sel_hi:[1,0,1] neg_lo:[0,1,0] neg_hi:[0,1,0]
    v_exp_f32 v70, v212
    v_exp_f32 v71, v213
    v_pk_fma_f32 v[220:221], v[44:45], v[52:53], v[220:221] op_sel_hi:[1,0,1] neg_lo:[0,1,0] neg_hi:[0,1,0]
    v_exp_f32 v72, v214
    v_exp_f32 v73, v215
    v_pk_fma_f32 v[222:223], v[46:47], v[52:53], v[222:223] op_sel_hi:[1,0,1] neg_lo:[0,1,0] neg_hi:[0,1,0]
    v_pk_add_f32 v[66:67], v[66:67], 1.0 op_sel_hi:[1,0]
    v_pk_add_f32 v[68:69], v[68:69], 1.0 op_sel_hi:[1,0]
    v_pk_add_f32 v[70:71], v[70:71], 1.0 op_sel_hi:[1,0]
    v_pk_add_f32 v[72:73], v[72:73], 1.0 op_sel_hi:[1,0]
    v_rcp_f32 v66, v66
    v_rcp_f32 v67, v67
    v_pk_mul_f32 v[208:209], v[208:209], v[216:217]
    v_rcp_f32 v68, v68
    v_rcp_f32 v69, v69
    v_pk_mul_f32 v[210:211], v[210:211], v[218:219]
    v_rcp_f32 v70, v70
    v_rcp_f32 v71, v71
    v_pk_mul_f32 v[212:213], v[212:213], v[220:221]
    v_rcp_f32 v72, v72
    v_rcp_f32 v73, v73
    v_pk_mul_f32 v[214:215], v[214:215], v[222:223]
    v_pk_mul_f32 v[208:209], v[208:209], v[66:67]
    v_pk_mul_f32 v[210:211], v[210:211], v[68:69]
    v_pk_mul_f32 v[212:213], v[212:213], v[70:71]
    v_pk_mul_f32 v[214:215], v[214:215], v[72:73]
    v_cvt_pk_bf16_f32 v84, v208, v209
    v_cvt_pk_bf16_f32 v85, v210, v211
    v_cvt_pk_bf16_f32 v86, v212, v213
    v_cvt_pk_bf16_f32 v87, v214, v215
    buffer_store_dwordx4 v[84:87], v6, s[40:43], s54 offen offset:1024 sc1
    v_pk_fma_f32 v[240:241], v[32:33], v[54:55], v[240:241] op_sel_hi:[1,0,1] neg_lo:[0,1,0] neg_hi:[0,1,0]
    v_pk_fma_f32 v[242:243], v[34:35], v[54:55], v[242:243] op_sel_hi:[1,0,1] neg_lo:[0,1,0] neg_hi:[0,1,0]
    v_pk_fma_f32 v[244:245], v[36:37], v[54:55], v[244:245] op_sel_hi:[1,0,1] neg_lo:[0,1,0] neg_hi:[0,1,0]
    v_pk_fma_f32 v[246:247], v[38:39], v[54:55], v[246:247] op_sel_hi:[1,0,1] neg_lo:[0,1,0] neg_hi:[0,1,0]
    v_pk_mul_f32 v[240:241], v[240:241], v[64:65] op_sel_hi:[1,0]
    v_pk_mul_f32 v[242:243], v[242:243], v[64:65] op_sel_hi:[1,0]
    v_pk_mul_f32 v[244:245], v[244:245], v[64:65] op_sel_hi:[1,0]
    v_pk_mul_f32 v[246:247], v[246:247], v[64:65] op_sel_hi:[1,0]
    v_exp_f32 v74, v240
    v_exp_f32 v75, v241
    v_pk_fma_f32 v[248:249], v[40:41], v[54:55], v[248:249] op_sel_hi:[1,0,1] neg_lo:[0,1,0] neg_hi:[0,1,0]
    v_exp_f32 v76, v242
    v_exp_f32 v77, v243
    v_pk_fma_f32 v[250:251], v[42:43], v[54:55], v[250:251] op_sel_hi:[1,0,1] neg_lo:[0,1,0] neg_hi:[0,1,0]
    v_exp_f32 v78, v244
    v_exp_f32 v79, v245
    v_pk_fma_f32 v[252:253], v[44:45], v[54:55], v[252:253] op_sel_hi:[1,0,1] neg_lo:[0,1,0] neg_hi:[0,1,0]
    v_exp_f32 v80, v246
    v_exp_f32 v81, v247
    v_pk_fma_f32 v[254:255], v[46:47], v[54:55], v[254:255] op_sel_hi:[1,0,1] neg_lo:[0,1,0] neg_hi:[0,1,0]
    v_pk_add_f32 v[74:75], v[74:75], 1.0 op_sel_hi:[1,0]
    v_pk_add_f32 v[76:77], v[76:77], 1.0 op_sel_hi:[1,0]
    v_pk_add_f32 v[78:79], v[78:79], 1.0 op_sel_hi:[1,0]
    v_pk_add_f32 v[80:81], v[80:81], 1.0 op_sel_hi:[1,0]
    v_rcp_f32 v74, v74
    v_rcp_f32 v75, v75
    v_pk_mul_f32 v[240:241], v[240:241], v[248:249]
    v_rcp_f32 v76, v76
    v_rcp_f32 v77, v77
    v_pk_mul_f32 v[242:243], v[242:243], v[250:251]
    v_rcp_f32 v78, v78
    v_rcp_f32 v79, v79
    v_pk_mul_f32 v[244:245], v[244:245], v[252:253]
    v_rcp_f32 v80, v80
    v_rcp_f32 v81, v81
    v_pk_mul_f32 v[246:247], v[246:247], v[254:255]
    v_pk_mul_f32 v[240:241], v[240:241], v[74:75]
    v_pk_mul_f32 v[242:243], v[242:243], v[76:77]
    v_pk_mul_f32 v[244:245], v[244:245], v[78:79]
    v_pk_mul_f32 v[246:247], v[246:247], v[80:81]
    v_cvt_pk_bf16_f32 v88, v240, v241
    v_cvt_pk_bf16_f32 v89, v242, v243
    v_cvt_pk_bf16_f32 v90, v244, v245
    v_cvt_pk_bf16_f32 v91, v246, v247
    buffer_store_dwordx4 v[88:91], v6, s[40:43], s55 offen offset:1024 sc1
    s_waitcnt vmcnt(4)
    v_mov_b32 v12, s82
    v_mov_b32 v13, s83
    s_mov_b64 exec, 1
    buffer_store_dwordx2 v[12:13], off, s[40:43], s48 sc1
    s_mov_b64 exec, -1
    v_mov_b32 v12, 162956
    v_mov_b32 v13, 1
    s_mov_b64 exec, 1
    ds_add_u32 v12, v13
    s_mov_b64 exec, -1
L_cE:
    s_setprio 3
    v_mov_b32 v12, s51
L_lagain_18:
    ds_read_b32 v13, v12
    s_waitcnt lgkmcnt(0)
    v_cmp_eq_u32 vcc, 1, v13
    s_cbranch_vccnz L_lok_17
    s_sleep 1
    s_branch L_lagain_18
L_lok_17:
    v_add_u32 v10, 98304, v2
    v_add_u32 v11, 98304, v3
    v_add_u32 v12, 98304, v7
    v_add_u32 v13, 98304, v8
    ds_read_b64_tr_b16 v[96:97], v10 offset:0
    ds_read_b64_tr_b16 v[98:99], v10 offset:2048
    ds_read_b64_tr_b16 v[100:101], v11 offset:0
    ds_read_b64_tr_b16 v[102:103], v11 offset:2048
    ds_read_b64_tr_b16 v[104:105], v12 offset:0
    ds_read_b64_tr_b16 v[106:107], v12 offset:2048
    ds_read_b64_tr_b16 v[108:109], v13 offset:0
    ds_read_b64_tr_b16 v[110:111], v13 offset:2048
    ds_read_b64_tr_b16 v[112:113], v10 offset:4096
    ds_read_b64_tr_b16 v[114:115], v10 offset:6144
    ds_read_b64_tr_b16 v[116:117], v11 offset:4096
    ds_read_b64_tr_b16 v[118:119], v11 offset:6144
    ds_read_b64_tr_b16 v[120:121], v12 offset:4096
    ds_read_b64_tr_b16 v[122:123], v12 offset:6144
    ds_read_b64_tr_b16 v[124:125], v13 offset:4096
    ds_read_b64_tr_b16 v[126:127], v13 offset:6144
    ds_read_b64_tr_b16 v[128:129], v10 offset:8192
    ds_read_b64_tr_b16 v[130:131], v10 offset:10240
    ds_read_b64_tr_b16 v[132:133], v11 offset:8192
    ds_read_b64_tr_b16 v[134:135], v11 offset:10240
    ds_read_b64_tr_b16 v[136:137], v12 offset:8192
    ds_read_b64_tr_b16 v[138:139], v12 offset:10240
    ds_read_b64_tr_b16 v[140:141], v13 offset:8192
    ds_read_b64_tr_b16 v[142:143], v13 offset:10240
    ds_read_b64_tr_b16 v[144:145], v2 offset:0
    ds_read_b64_tr_b16 v[146:147], v2 offset:2048
    ds_read_b64_tr_b16 v[148:149], v3 offset:0
    ds_read_b64_tr_b16 v[150:151], v3 offset:2048
    ds_read_b64_tr_b16 v[152:153], v7 offset:0
    ds_read_b64_tr_b16 v[154:155], v7 offset:2048
    ds_read_b64_tr_b16 v[156:157], v8 offset:0
    ds_read_b64_tr_b16 v[158:159], v8 offset:2048
    ds_read_b64_tr_b16 v[160:161], v2 offset:4096
    ds_read_b64_tr_b16 v[162:163], v2 offset:6144
    ds_read_b64_tr_b16 v[164:165], v3 offset:4096
    ds_read_b64_tr_b16 v[166:167], v3 offset:6144
    ds_read_b64_tr_b16 v[168:169], v7 offset:4096
    ds_read_b64_tr_b16 v[170:171], v7 offset:6144
    ds_read_b64_tr_b16 v[172:173], v8 offset:4096
    ds_read_b64_tr_b16 v[174:175], v8 offset:6144
    ds_read_b64_tr_b16 v[176:177], v2 offset:8192
    ds_read_b64_tr_b16 v[178:179], v2 offset:10240
    ds_read_b64_tr_b16 v[180:181], v3 offset:8192
    ds_read_b64_tr_b16 v[182:183], v3 offset:10240
    ds_read_b64_tr_b16 v[184:185], v7 offset:8192
    ds_read_b64_tr_b16 v[186:187], v7 offset:10240
    ds_read_b64_tr_b16 v[188:189], v8 offset:8192
    ds_read_b64_tr_b16 v[190:191], v8 offset:10240
    s_mul_i32 s90, s81, 12288
    s_add_u32 s92, s32, 6
    s_cmp_ge_u32 s92, 7
    s_cselect_b32 s85, 7, 0
    s_sub_u32 s92, s92, s85
    s_mov_b32 s93, s32
    v_add_u32 v14, 57344, v6
    v_add_u32 v15, 114688, v6
    v_add_u32 v4, 172032, v6
    s_add_u32 s48, s48, 128
    s_waitcnt lgkmcnt(0)
    s_load_dwordx16 s[56:71], s[40:41], s49 glc
    s_lshl_b32 s86, s92, 16
    s_add_u32 m0, s90, 98304
    s_add_u32 s92, s92, 1
    s_cmp_eq_u32 s92, 7
    s_cselect_b32 s92, 0, s92
    buffer_load_dwordx4 v9, s[28:31], s86 offen  lds
    s_add_u32 m0, s90, 99328
    s_add_u32 s86, s86, 8192
    buffer_load_dwordx4 v9, s[28:31], s86 offen  lds
    s_add_u32 m0, s90, 100352
    s_add_u32 s86, s86, 8192
    buffer_load_dwordx4 v9, s[28:31], s86 offen  lds
    s_add_u32 m0, s90, 101376
    s_add_u32 s86, s86, 8192
    buffer_load_dwordx4 v9, s[28:31], s86 offen  lds
    s_lshl_b32 s86, s92, 16
    s_add_u32 s86, s86, 32768
    s_add_u32 m0, s90, 102400
    s_add_u32 s92, s92, 1
    s_cmp_eq_u32 s92, 7
    s_cselect_b32 s92, 0, s92
    buffer_load_dwordx4 v9, s[28:31], s86 offen  lds
    s_add_u32 m0, s90, 103424
    s_add_u32 s86, s86, 8192
    buffer_load_dwordx4 v9, s[28:31], s86 offen  lds
    s_add_u32 m0, s90, 104448
    s_add_u32 s86, s86, 8192
    buffer_load_dwordx4 v9, s[28:31], s86 offen  lds
    s_add_u32 m0, s90, 105472
    s_add_u32 s86, s86, 8192
    buffer_load_dwordx4 v9, s[28:31], s86 offen  lds
    s_lshl_b32 s86, s92, 16
    s_add_u32 s86, s86, 32768
    s_add_u32 m0, s90, 106496
    s_add_u32 s92, s92, 1
    s_cmp_eq_u32 s92, 7
    s_cselect_b32 s92, 0, s92
    buffer_load_dwordx4 v9, s[28:31], s86 offen  lds
    s_add_u32 m0, s90, 107520
    s_add_u32 s86, s86, 8192
    buffer_load_dwordx4 v9, s[28:31], s86 offen  lds
    s_add_u32 m0, s90, 108544
    s_add_u32 s86, s86, 8192
    buffer_load_dwordx4 v9, s[28:31], s86 offen  lds
    s_add_u32 m0, s90, 109568
    s_add_u32 s86, s86, 8192
    buffer_load_dwordx4 v9, s[28:31], s86 offen  lds
    s_lshl_b32 s86, s92, 16
    s_add_u32 s86, s86, 32768
    s_add_u32 m0, s90, 0
    s_add_u32 s92, s92, 1
    s_cmp_eq_u32 s92, 7
    s_cselect_b32 s92, 0, s92
    buffer_load_dwordx4 v9, s[28:31], s86 offen  lds
    s_add_u32 m0, s90, 1024
    s_add_u32 s86, s86, 8192
    buffer_load_dwordx4 v9, s[28:31], s86 offen  lds
    s_add_u32 m0, s90, 2048
    s_add_u32 s86, s86, 8192
    buffer_load_dwordx4 v9, s[28:31], s86 offen  lds
    s_add_u32 m0, s90, 3072
    s_add_u32 s86, s86, 8192
    buffer_load_dwordx4 v9, s[28:31], s86 offen  lds
    s_waitcnt vmcnt(17) lgkmcnt(0)
    v_mov_b32 v16, s82
    v_mov_b32 v17, s83
    s_mov_b64 exec, 1
    buffer_store_dwordx2 v[16:17], off, s[40:43], s48 sc1
    s_mov_b64 exec, -1
    s_xor_b64 s[56:57], s[56:57], s[82:83]
    s_xor_b64 s[58:59], s[58:59], s[82:83]
    s_or_b64 s[56:57], s[56:57], s[58:59]
    s_xor_b64 s[60:61], s[60:61], s[82:83]
    s_or_b64 s[56:57], s[56:57], s[60:61]
    s_xor_b64 s[62:63], s[62:63], s[82:83]
    s_or_b64 s[56:57], s[56:57], s[62:63]
    s_xor_b64 s[64:65], s[64:65], s[82:83]
    s_or_b64 s[56:57], s[56:57], s[64:65]
    s_xor_b64 s[66:67], s[66:67], s[82:83]
    s_or_b64 s[56:57], s[56:57], s[66:67]
    s_xor_b64 s[68:69], s[68:69], s[82:83]
    s_or_b64 s[56:57], s[56:57], s[68:69]
    s_cbranch_scc0 L_hA
    s_mov_b32 s33, 262144
L_sagain_20:
    s_load_dwordx16 s[56:71], s[40:41], s49 glc
    s_sub_u32 s33, s33, 1
    s_cbranch_scc1 L_sok_19
    s_waitcnt lgkmcnt(0)
    s_xor_b64 s[56:57], s[56:57], s[82:83]
    s_xor_b64 s[58:59], s[58:59], s[82:83]
    s_or_b64 s[56:57], s[56:57], s[58:59]
    s_xor_b64 s[60:61], s[60:61], s[82:83]
    s_or_b64 s[56:57], s[56:57], s[60:61]
    s_xor_b64 s[62:63], s[62:63], s[82:83]
    s_or_b64 s[56:57], s[56:57], s[62:63]
    s_xor_b64 s[64:65], s[64:65], s[82:83]
    s_or_b64 s[56:57], s[56:57], s[64:65]
    s_xor_b64 s[66:67], s[66:67], s[82:83]
    s_or_b64 s[56:57], s[56:57], s[66:67]
    s_xor_b64 s[68:69], s[68:69], s[82:83]
    s_or_b64 s[56:57], s[56:57], s[68:69]
    s_cbranch_scc0 L_sok_19
    s_sleep 8
    s_branch L_sagain_20
L_sok_19:
L_hA:
    s_add_u32 s49, s49, 128
    s_nop 0
    s_lshl_b32 s89, s93, 11
    s_add_u32 s89, s89, s50
    s_add_u32 s93, s93, 1
    s_cmp_eq_u32 s93, 7
    s_cselect_b32 s93, 0, s93
    buffer_load_dwordx4 v[16:19], v6, s[40:43], s89 offen sc1
    buffer_load_dwordx4 v[20:23], v14, s[40:43], s89 offen sc1
    buffer_load_dwordx4 v[24:27], v15, s[40:43], s89 offen sc1
    buffer_load_dwordx4 v[28:31], v4, s[40:43], s89 offen sc1
    s_lshl_b32 s89, s93, 11
    s_add_u32 s89, s89, s50
    s_add_u32 s93, s93, 1
    s_cmp_eq_u32 s93, 7
    s_cselect_b32 s93, 0, s93
    buffer_load_dwordx4 v[32:35], v6, s[40:43], s89 offen sc1
    buffer_load_dwordx4 v[36:39], v14, s[40:43], s89 offen sc1
    buffer_load_dwordx4 v[40:43], v15, s[40:43], s89 offen sc1
    buffer_load_dwordx4 v[44:47], v4, s[40:43], s89 offen sc1
    s_lshl_b32 s89, s93, 11
    s_add_u32 s89, s89, s50
    s_add_u32 s93, s93, 1
    s_cmp_eq_u32 s93, 7
    s_cselect_b32 s93, 0, s93
    buffer_load_dwordx4 v[48:51], v6, s[40:43], s89 offen sc1
    buffer_load_dwordx4 v[52:55], v14, s[40:43], s89 offen sc1
    buffer_load_dwordx4 v[56:59], v15, s[40:43], s89 offen sc1
    buffer_load_dwordx4 v[60:63], v4, s[40:43], s89 offen sc1
    s_lshl_b32 s89, s93, 11
    s_add_u32 s89, s89, s50
    s_add_u32 s93, s93, 1
    s_cmp_eq_u32 s93, 7
    s_cselect_b32 s93, 0, s93
    buffer_load_dwordx4 v[64:67], v6, s[40:43], s89 offen sc1
    buffer_load_dwordx4 v[68:71], v14, s[40:43], s89 offen sc1
    buffer_load_dwordx4 v[72:75], v15, s[40:43], s89 offen sc1
    buffer_load_dwordx4 v[76:79], v4, s[40:43], s89 offen sc1
    s_lshl_b32 s55, s93, 11
    s_add_u32 s55, s55, s50
    s_add_u32 s93, s93, 1
    s_cmp_eq_u32 s93, 7
    s_cselect_b32 s93, 0, s93
    s_setprio 0
    s_waitcnt vmcnt(12)
    v_mfma_f32_16x16x32_bf16 v[192:195], v[96:99], v[16:19], 0
    v_mfma_f32_16x16x32_bf16 v[196:199], v[100:103], v[16:19], 0
    v_mfma_f32_16x16x32_bf16 v[200:203], v[104:107], v[16:19], 0
    v_mfma_f32_16x16x32_bf16 v[204:207], v[108:111], v[16:19], 0
    v_mfma_f32_16x16x32_bf16 v[208:211], v[96:99], v[20:23], 0
    v_mfma_f32_16x16x32_bf16 v[212:215], v[100:103], v[20:23], 0
    v_mfma_f32_16x16x32_bf16 v[216:219], v[104:107], v[20:23], 0
    v_mfma_f32_16x16x32_bf16 v[220:223], v[108:111], v[20:23], 0
    v_mfma_f32_16x16x32_bf16 v[224:227], v[96:99], v[24:27], 0
    v_mfma_f32_16x16x32_bf16 v[228:231], v[100:103], v[24:27], 0
    v_mfma_f32_16x16x32_bf16 v[232:235], v[104:107], v[24:27], 0
    v_mfma_f32_16x16x32_bf16 v[236:239], v[108:111], v[24:27], 0
    v_mfma_f32_16x16x32_bf16 v[240:243], v[96:99], v[28:31], 0
    v_mfma_f32_16x16x32_bf16 v[244:247], v[100:103], v[28:31], 0
    v_mfma_f32_16x16x32_bf16 v[248:251], v[104:107], v[28:31], 0
    v_mfma_f32_16x16x32_bf16 v[252:255], v[108:111], v[28:31], 0
    s_lshl_b32 s86, s92, 16
    s_add_u32 s86, s86, 32768
    s_add_u32 m0, s90, 4096
    s_add_u32 s92, s92, 1
    s_cmp_eq_u32 s92, 7
    s_cselect_b32 s92, 0, s92
    buffer_load_dwordx4 v9, s[28:31], s86 offen  lds
    s_add_u32 m0, s90, 5120
    s_add_u32 s86, s86, 8192
    buffer_load_dwordx4 v9, s[28:31], s86 offen  lds
    s_add_u32 m0, s90, 6144
    s_add_u32 s86, s86, 8192
    buffer_load_dwordx4 v9, s[28:31], s86 offen  lds
    s_add_u32 m0, s90, 7168
    s_add_u32 s86, s86, 8192
    buffer_load_dwordx4 v9, s[28:31], s86 offen  lds
    s_waitcnt vmcnt(12)
    v_mfma_f32_16x16x32_bf16 v[192:195], v[112:115], v[32:35], v[192:195]
    v_mfma_f32_16x16x32_bf16 v[196:199], v[116:119], v[32:35], v[196:199]
    buffer_load_dwordx4 v[16:19], v6, s[40:43], s55 offen sc1
    v_mfma_f32_16x16x32_bf16 v[200:203], v[120:123], v[32:35], v[200:203]
    s_lshl_b32 s54, s93, 11
    v_mfma_f32_16x16x32_bf16 v[204:207], v[124:127], v[32:35], v[204:207]
    s_add_u32 s54, s54, s50
    v_mfma_f32_16x16x32_bf16 v[208:211], v[112:115], v[36:39], v[208:211]
    s_add_u32 s93, s93, 1
    v_mfma_f32_16x16x32_bf16 v[212:215], v[116:119], v[36:39], v[212:215]
    buffer_load_dwordx4 v[20:23], v14, s[40:43], s55 offen sc1
    s_cmp_eq_u32 s93, 7
    v_mfma_f32_16x16x32_bf16 v[216:219], v[120:123], v[36:39], v[216:219]
    s_cselect_b32 s93, 0, s93
    v_mfma_f32_16x16x32_bf16 v[220:223], v[124:127], v[36:39], v[220:223]
    v_mfma_f32_16x16x32_bf16 v[224:227], v[112:115], v[40:43], v[224:227]
    v_mfma_f32_16x16x32_bf16 v[228:231], v[116:119], v[40:43], v[228:231]
    buffer_load_dwordx4 v[24:27], v15, s[40:43], s55 offen sc1
    v_mfma_f32_16x16x32_bf16 v[232:235], v[120:123], v[40:43], v[232:235]
    v_mfma_f32_16x16x32_bf16 v[236:239], v[124:127], v[40:43], v[236:239]
    v_mfma_f32_16x16x32_bf16 v[240:243], v[112:115], v[44:47], v[240:243]
    v_mfma_f32_16x16x32_bf16 v[244:247], v[116:119], v[44:47], v[244:247]
    buffer_load_dwordx4 v[28:31], v4, s[40:43], s55 offen sc1
    v_mfma_f32_16x16x32_bf16 v[248:251], v[120:123], v[44:47], v[248:251]
    v_mfma_f32_16x16x32_bf16 v[252:255], v[124:127], v[44:47], v[252:255]
    s_lshl_b32 s86, s92, 16
    s_add_u32 s86, s86, 32768
    s_add_u32 m0, s90, 8192
    s_add_u32 s92, s92, 1
    s_cmp_eq_u32 s92, 7
    s_cselect_b32 s92, 0, s92
    buffer_load_dwordx4 v9, s[28:31], s86 offen  lds
    s_add_u32 m0, s90, 9216
    s_add_u32 s86, s86, 8192
    buffer_load_dwordx4 v9, s[28:31], s86 offen  lds
    s_add_u32 m0, s90, 10240
    s_add_u32 s86, s86, 8192
    buffer_load_dwordx4 v9, s[28:31], s86 offen  lds
    s_add_u32 m0, s90, 11264
    s_add_u32 s86, s86, 8192
    buffer_load_dwordx4 v9, s[28:31], s86 offen  lds
    s_waitcnt vmcnt(16)
    v_mfma_f32_16x16x32_bf16 v[192:195], v[128:131], v[48:51], v[192:195]
    s_load_dwordx16 s[56:71], s[40:41], s49 glc
    v_mfma_f32_16x16x32_bf16 v[196:199], v[132:135], v[48:51], v[196:199]
    buffer_load_dwordx4 v[32:35], v6, s[40:43], s54 offen sc1
    v_mfma_f32_16x16x32_bf16 v[200:203], v[136:139], v[48:51], v[200:203]
    s_lshl_b32 s55, s93, 11
    v_mfma_f32_16x16x32_bf16 v[204:207], v[140:143], v[48:51], v[204:207]
    s_add_u32 s55, s55, s50
    v_mfma_f32_16x16x32_bf16 v[208:211], v[128:131], v[52:55], v[208:211]
    s_add_u32 s93, s93, 1
    v_mfma_f32_16x16x32_bf16 v[212:215], v[132:135], v[52:55], v[212:215]
    buffer_load_dwordx4 v[36:39], v14, s[40:43], s54 offen sc1
    s_cmp_eq_u32 s93, 7
    v_mfma_f32_16x16x32_bf16 v[216:219], v[136:139], v[52:55], v[216:219]
    s_cselect_b32 s93, 0, s93
    v_mfma_f32_16x16x32_bf16 v[220:223], v[140:143], v[52:55], v[220:223]
    v_mfma_f32_16x16x32_bf16 v[224:227], v[128:131], v[56:59], v[224:227]
    v_mfma_f32_16x16x32_bf16 v[228:231], v[132:135], v[56:59], v[228:231]
    buffer_load_dwordx4 v[40:43], v15, s[40:43], s54 offen sc1
    v_mfma_f32_16x16x32_bf16 v[232:235], v[136:139], v[56:59], v[232:235]
    v_mfma_f32_16x16x32_bf16 v[236:239], v[140:143], v[56:59], v[236:239]
    v_mfma_f32_16x16x32_bf16 v[240:243], v[128:131], v[60:63], v[240:243]
    v_mfma_f32_16x16x32_bf16 v[244:247], v[132:135], v[60:63], v[244:247]
    buffer_load_dwordx4 v[44:47], v4, s[40:43], s54 offen sc1
    v_mfma_f32_16x16x32_bf16 v[248:251], v[136:139], v[60:63], v[248:251]
    v_mfma_f32_16x16x32_bf16 v[252:255], v[140:143], v[60:63], v[252:255]
    s_waitcnt vmcnt(16)
    v_mfma_f32_16x16x32_bf16 v[192:195], v[144:147], v[64:67], v[192:195]
    v_mfma_f32_16x16x32_bf16 v[196:199], v[148:151], v[64:67], v[196:199]
    buffer_load_dwordx4 v[48:51], v6, s[40:43], s55 offen sc1
    v_mfma_f32_16x16x32_bf16 v[200:203], v[152:155], v[64:67], v[200:203]
    s_lshl_b32 s54, s93, 11
    v_mfma_f32_16x16x32_bf16 v[204:207], v[156:159], v[64:67], v[204:207]
    s_add_u32 s54, s54, 1024
    v_mfma_f32_16x16x32_bf16 v[208:211], v[144:147], v[68:71], v[208:211]
    s_add_u32 s54, s54, s50
    v_mfma_f32_16x16x32_bf16 v[212:215], v[148:151], v[68:71], v[212:215]
    buffer_load_dwordx4 v[52:55], v14, s[40:43], s55 offen sc1
    s_add_u32 s93, s93, 1
    v_mfma_f32_16x16x32_bf16 v[216:219], v[152:155], v[68:71], v[216:219]
    s_cmp_eq_u32 s93, 7
    v_mfma_f32_16x16x32_bf16 v[220:223], v[156:159], v[68:71], v[220:223]
    s_cselect_b32 s93, 0, s93
    v_mfma_f32_16x16x32_bf16 v[224:227], v[144:147], v[72:75], v[224:227]
    v_mfma_f32_16x16x32_bf16 v[228:231], v[148:151], v[72:75], v[228:231]
    buffer_load_dwordx4 v[56:59], v15, s[40:43], s55 offen sc1
    v_mfma_f32_16x16x32_bf16 v[232:235], v[152:155], v[72:75], v[232:235]
    v_mfma_f32_16x16x32_bf16 v[236:239], v[156:159], v[72:75], v[236:239]
    v_mfma_f32_16x16x32_bf16 v[240:243], v[144:147], v[76:79], v[240:243]
    v_mfma_f32_16x16x32_bf16 v[244:247], v[148:151], v[76:79], v[244:247]
    buffer_load_dwordx4 v[60:63], v4, s[40:43], s55 offen sc1
    v_mfma_f32_16x16x32_bf16 v[248:251], v[152:155], v[76:79], v[248:251]
    v_mfma_f32_16x16x32_bf16 v[252:255], v[156:159], v[76:79], v[252:255]
    s_waitcnt vmcnt(12) lgkmcnt(0)
    s_xor_b64 s[56:57], s[56:57], s[82:83]
    s_xor_b64 s[58:59], s[58:59], s[82:83]
    s_or_b64 s[56:57], s[56:57], s[58:59]
    s_xor_b64 s[60:61], s[60:61], s[82:83]
    s_or_b64 s[56:57], s[56:57], s[60:61]
    s_xor_b64 s[62:63], s[62:63], s[82:83]
    s_or_b64 s[56:57], s[56:57], s[62:63]
    s_xor_b64 s[64:65], s[64:65], s[82:83]
    s_or_b64 s[56:57], s[56:57], s[64:65]
    s_xor_b64 s[66:67], s[66:67], s[82:83]
    s_or_b64 s[56:57], s[56:57], s[66:67]
    s_xor_b64 s[68:69], s[68:69], s[82:83]
    s_or_b64 s[56:57], s[56:57], s[68:69]
    s_cbranch_scc0 L_hB
    s_mov_b32 s33, 262144
L_sagain_22:
    s_load_dwordx16 s[56:71], s[40:41], s49 glc
    s_sub_u32 s33, s33, 1
    s_cbranch_scc1 L_sok_21
    s_waitcnt lgkmcnt(0)
    s_xor_b64 s[56:57], s[56:57], s[82:83]
    s_xor_b64 s[58:59], s[58:59], s[82:83]
    s_or_b64 s[56:57], s[56:57], s[58:59]
    s_xor_b64 s[60:61], s[60:61], s[82:83]
    s_or_b64 s[56:57], s[56:57], s[60:61]
    s_xor_b64 s[62:63], s[62:63], s[82:83]
    s_or_b64 s[56:57], s[56:57], s[62:63]
    s_xor_b64 s[64:65], s[64:65], s[82:83]
    s_or_b64 s[56:57], s[56:57], s[64:65]
    s_xor_b64 s[66:67], s[66:67], s[82:83]
    s_or_b64 s[56:57], s[56:57], s[66:67]
    s_xor_b64 s[68:69], s[68:69], s[82:83]
    s_or_b64 s[56:57], s[56:57], s[68:69]
    s_cbranch_scc0 L_sok_21
    s_sleep 8
    s_branch L_sagain_22
L_sok_21:
L_hB:
    v_mfma_f32_16x16x32_bf16 v[192:195], v[160:163], v[16:19], v[192:195]
    v_mfma_f32_16x16x32_bf16 v[196:199], v[164:167], v[16:19], v[196:199]
    buffer_load_dwordx4 v[64:67], v6, s[40:43], s54 offen sc1
    v_mfma_f32_16x16x32_bf16 v[200:203], v[168:171], v[16:19], v[200:203]
    s_lshl_b32 s55, s93, 11
    v_mfma_f32_16x16x32_bf16 v[204:207], v[172:175], v[16:19], v[204:207]
    s_add_u32 s55, s55, 1024
    v_mfma_f32_16x16x32_bf16 v[208:211], v[160:163], v[20:23], v[208:211]
    s_add_u32 s55, s55, s50
    v_mfma_f32_16x16x32_bf16 v[212:215], v[164:167], v[20:23], v[212:215]
    buffer_load_dwordx4 v[68:71], v14, s[40:43], s54 offen sc1
    s_add_u32 s93, s93, 1
    v_mfma_f32_16x16x32_bf16 v[216:219], v[168:171], v[20:23], v[216:219]
    s_cmp_eq_u32 s93, 7
    v_mfma_f32_16x16x32_bf16 v[220:223], v[172:175], v[20:23], v[220:223]
    s_cselect_b32 s93, 0, s93
    v_mfma_f32_16x16x32_bf16 v[224:227], v[160:163], v[24:27], v[224:227]
    v_mfma_f32_16x16x32_bf16 v[228:231], v[164:167], v[24:27], v[228:231]
    buffer_load_dwordx4 v[72:75], v15, s[40:43], s54 offen sc1
    v_mfma_f32_16x16x32_bf16 v[232:235], v[168:171], v[24:27], v[232:235]
    v_mfma_f32_16x16x32_bf16 v[236:239], v[172:175], v[24:27], v[236:239]
    v_mfma_f32_16x16x32_bf16 v[240:243], v[160:163], v[28:31], v[240:243]
    v_mfma_f32_16x16x32_bf16 v[244:247], v[164:167], v[28:31], v[244:247]
    buffer_load_dwordx4 v[76:79], v4, s[40:43], s54 offen sc1
    v_mfma_f32_16x16x32_bf16 v[248:251], v[168:171], v[28:31], v[248:251]
    v_mfma_f32_16x16x32_bf16 v[252:255], v[172:175], v[28:31], v[252:255]
    s_waitcnt vmcnt(8)
    v_mfma_f32_16x16x32_bf16 v[192:195], v[176:179], v[32:35], v[192:195]
    ds_read_b64_tr_b16 v[96:97], v10 offset:0
    s_lshl_b32 s54, s93, 11
    v_mfma_f32_16x16x32_bf16 v[196:199], v[180:183], v[32:35], v[196:199]
    ds_read_b64_tr_b16 v[98:99], v10 offset:2048
    s_add_u32 s54, s54, 1024
    v_mfma_f32_16x16x32_bf16 v[200:203], v[184:187], v[32:35], v[200:203]
    ds_read_b64_tr_b16 v[100:101], v11 offset:0
    s_add_u32 s54, s54, s50
    v_mfma_f32_16x16x32_bf16 v[204:207], v[188:191], v[32:35], v[204:207]
    ds_read_b64_tr_b16 v[102:103], v11 offset:2048
    s_add_u32 s93, s93, 1
    v_mfma_f32_16x16x32_bf16 v[208:211], v[176:179], v[36:39], v[208:211]
    ds_read_b64_tr_b16 v[104:105], v12 offset:0
    s_cmp_eq_u32 s93, 7
    v_mfma_f32_16x16x32_bf16 v[212:215], v[180:183], v[36:39], v[212:215]
    ds_read_b64_tr_b16 v[106:107], v12 offset:2048
    s_cselect_b32 s93, 0, s93
    v_mfma_f32_16x16x32_bf16 v[216:219], v[184:187], v[36:39], v[216:219]
    ds_read_b64_tr_b16 v[108:109], v13 offset:0
    v_mfma_f32_16x16x32_bf16 v[220:223], v[188:191], v[36:39], v[220:223]
    ds_read_b64_tr_b16 v[110:111], v13 offset:2048
    v_mfma_f32_16x16x32_bf16 v[224:227], v[176:179], v[40:43], v[224:227]
    buffer_load_dwordx4 v[16:19], v6, s[40:43], s55 offen sc1
    v_mfma_f32_16x16x32_bf16 v[228:231], v[180:183], v[40:43], v[228:231]
    v_mfma_f32_16x16x32_bf16 v[232:235], v[184:187], v[40:43], v[232:235]
    buffer_load_dwordx4 v[20:23], v14, s[40:43], s55 offen sc1
    v_mfma_f32_16x16x32_bf16 v[236:239], v[188:191], v[40:43], v[236:239]
    v_mfma_f32_16x16x32_bf16 v[240:243], v[176:179], v[44:47], v[240:243]
    buffer_load_dwordx4 v[24:27], v15, s[40:43], s55 offen sc1
    v_mfma_f32_16x16x32_bf16 v[244:247], v[180:183], v[44:47], v[244:247]
    v_mfma_f32_16x16x32_bf16 v[248:251], v[184:187], v[44:47], v[248:251]
    buffer_load_dwordx4 v[28:31], v4, s[40:43], s55 offen sc1
    v_mfma_f32_16x16x32_bf16 v[252:255], v[188:191], v[44:47], v[252:255]
    s_waitcnt vmcnt(8) lgkmcnt(0)
    v_mfma_f32_16x16x32_bf16 v[192:195], v[96:99], v[48:51], v[192:195]
    ds_read_b64_tr_b16 v[112:113], v10 offset:4096
    s_lshl_b32 s55, s93, 11
    v_mfma_f32_16x16x32_bf16 v[196:199], v[100:103], v[48:51], v[196:199]
    ds_read_b64_tr_b16 v[114:115], v10 offset:6144
    s_add_u32 s55, s55, 1024
    v_mfma_f32_16x16x32_bf16 v[200:203], v[104:107], v[48:51], v[200:203]
    ds_read_b64_tr_b16 v[116:117], v11 offset:4096
    s_add_u32 s55, s55, s50
    v_mfma_f32_16x16x32_bf16 v[204:207], v[108:111], v[48:51], v[204:207]
    ds_read_b64_tr_b16 v[118:119], v11 offset:6144
    s_add_u32 s93, s93, 1
    v_mfma_f32_16x16x32_bf16 v[208:211], v[96:99], v[52:55], v[208:211]
    ds_read_b64_tr_b16 v[120:121], v12 offset:4096
    s_cmp_eq_u32 s93, 7
    v_mfma_f32_16x16x32_bf16 v[212:215], v[100:103], v[52:55], v[212:215]
    ds_read_b64_tr_b16 v[122:123], v12 offset:6144
    s_cselect_b32 s93, 0, s93
    v_mfma_f32_16x16x32_bf16 v[216:219], v[104:107], v[52:55], v[216:219]
    ds_read_b64_tr_b16 v[124:125], v13 offset:4096
    v_mfma_f32_16x16x32_bf16 v[220:223], v[108:111], v[52:55], v[220:223]
    ds_read_b64_tr_b16 v[126:127], v13 offset:6144
    v_mfma_f32_16x16x32_bf16 v[224:227], v[96:99], v[56:59], v[224:227]
    buffer_load_dwordx4 v[32:35], v6, s[40:43], s54 offen sc1
    v_mfma_f32_16x16x32_bf16 v[228:231], v[100:103], v[56:59], v[228:231]
    v_mfma_f32_16x16x32_bf16 v[232:235], v[104:107], v[56:59], v[232:235]
    buffer_load_dwordx4 v[36:39], v14, s[40:43], s54 offen sc1
    v_mfma_f32_16x16x32_bf16 v[236:239], v[108:111], v[56:59], v[236:239]
    v_mfma_f32_16x16x32_bf16 v[240:243], v[96:99], v[60:63], v[240:243]
    buffer_load_dwordx4 v[40:43], v15, s[40:43], s54 offen sc1
    v_mfma_f32_16x16x32_bf16 v[244:247], v[100:103], v[60:63], v[244:247]
    v_mfma_f32_16x16x32_bf16 v[248:251], v[104:107], v[60:63], v[248:251]
    buffer_load_dwordx4 v[44:47], v4, s[40:43], s54 offen sc1
    v_mfma_f32_16x16x32_bf16 v[252:255], v[108:111], v[60:63], v[252:255]
    s_lshl_b32 s86, s92, 16
    s_add_u32 s86, s86, 32768
    s_add_u32 m0, s90, 98304
    s_add_u32 s92, s92, 1
    s_cmp_eq_u32 s92, 7
    s_cselect_b32 s92, 0, s92
    buffer_load_dwordx4 v9, s[28:31], s86 offen  lds
    s_add_u32 m0, s90, 99328
    s_add_u32 s86, s86, 8192
    buffer_load_dwordx4 v9, s[28:31], s86 offen  lds
    s_add_u32 m0, s90, 100352
    s_add_u32 s86, s86, 8192
    buffer_load_dwordx4 v9, s[28:31], s86 offen  lds
    s_add_u32 m0, s90, 101376
    s_add_u32 s86, s86, 8192
    buffer_load_dwordx4 v9, s[28:31], s86 offen  lds
    s_waitcnt vmcnt(12) lgkmcnt(0)
    v_mfma_f32_16x16x32_bf16 v[192:195], v[112:115], v[64:67], v[192:195]
    ds_read_b64_tr_b16 v[128:129], v10 offset:8192
    s_lshl_b32 s54, s93, 11
    v_mfma_f32_16x16x32_bf16 v[196:199], v[116:119], v[64:67], v[196:199]
    ds_read_b64_tr_b16 v[130:131], v10 offset:10240
    s_add_u32 s54, s54, 1024
    v_mfma_f32_16x16x32_bf16 v[200:203], v[120:123], v[64:67], v[200:203]
    ds_read_b64_tr_b16 v[132:133], v11 offset:8192
    s_add_u32 s54, s54, s50
    v_mfma_f32_16x16x32_bf16 v[204:207], v[124:127], v[64:67], v[204:207]
    ds_read_b64_tr_b16 v[134:135], v11 offset:10240
    s_add_u32 s93, s93, 1
    v_mfma_f32_16x16x32_bf16 v[208:211], v[112:115], v[68:71], v[208:211]
    ds_read_b64_tr_b16 v[136:137], v12 offset:8192
    s_cmp_eq_u32 s93, 7
    v_mfma_f32_16x16x32_bf16 v[212:215], v[116:119], v[68:71], v[212:215]
    ds_read_b64_tr_b16 v[138:139], v12 offset:10240
    s_cselect_b32 s93, 0, s93
    v_mfma_f32_16x16x32_bf16 v[216:219], v[120:123], v[68:71], v[216:219]
    ds_read_b64_tr_b16 v[140:141], v13 offset:8192
    v_mfma_f32_16x16x32_bf16 v[220:223], v[124:127], v[68:71], v[220:223]
    ds_read_b64_tr_b16 v[142:143], v13 offset:10240
    v_mfma_f32_16x16x32_bf16 v[224:227], v[112:115], v[72:75], v[224:227]
    buffer_load_dwordx4 v[48:51], v6, s[40:43], s55 offen sc1
    v_mfma_f32_16x16x32_bf16 v[228:231], v[116:119], v[72:75], v[228:231]
    v_mfma_f32_16x16x32_bf16 v[232:235], v[120:123], v[72:75], v[232:235]
    buffer_load_dwordx4 v[52:55], v14, s[40:43], s55 offen sc1
    v_mfma_f32_16x16x32_bf16 v[236:239], v[124:127], v[72:75], v[236:239]
    v_mfma_f32_16x16x32_bf16 v[240:243], v[112:115], v[76:79], v[240:243]
    buffer_load_dwordx4 v[56:59], v15, s[40:43], s55 offen sc1
    v_mfma_f32_16x16x32_bf16 v[244:247], v[116:119], v[76:79], v[244:247]
    v_mfma_f32_16x16x32_bf16 v[248:251], v[120:123], v[76:79], v[248:251]
    buffer_load_dwordx4 v[60:63], v4, s[40:43], s55 offen sc1
    v_mfma_f32_16x16x32_bf16 v[252:255], v[124:127], v[76:79], v[252:255]
    s_lshl_b32 s86, s92, 16
    s_add_u32 s86, s86, 32768
    s_add_u32 m0, s90, 102400
    s_add_u32 s92, s92, 1
    s_cmp_eq_u32 s92, 7
    s_cselect_b32 s92, 0, s92
    buffer_load_dwordx4 v9, s[28:31], s86 offen  lds
    s_add_u32 m0, s90, 103424
    s_add_u32 s86, s86, 8192
    buffer_load_dwordx4 v9, s[28:31], s86 offen  lds
    s_add_u32 m0, s90, 104448
    s_add_u32 s86, s86, 8192
    buffer_load_dwordx4 v9, s[28:31], s86 offen  lds
    s_add_u32 m0, s90, 105472
    s_add_u32 s86, s86, 8192
    buffer_load_dwordx4 v9, s[28:31], s86 offen  lds
    s_waitcnt vmcnt(16) lgkmcnt(0)
    v_mfma_f32_16x16x32_bf16 v[192:195], v[128:131], v[16:19], v[192:195]
    ds_read_b64_tr_b16 v[144:145], v2 offset:0
    s_lshl_b32 s55, s93, 11
    v_mfma_f32_16x16x32_bf16 v[196:199], v[132:135], v[16:19], v[196:199]
    ds_read_b64_tr_b16 v[146:147], v2 offset:2048
    s_add_u32 s55, s55, 1024
    v_mfma_f32_16x16x32_bf16 v[200:203], v[136:139], v[16:19], v[200:203]
    ds_read_b64_tr_b16 v[148:149], v3 offset:0
    s_add_u32 s55, s55, s50
    v_mfma_f32_16x16x32_bf16 v[204:207], v[140:143], v[16:19], v[204:207]
    ds_read_b64_tr_b16 v[150:151], v3 offset:2048
    s_add_u32 s93, s93, 1
    v_mfma_f32_16x16x32_bf16 v[208:211], v[128:131], v[20:23], v[208:211]
    ds_read_b64_tr_b16 v[152:153], v7 offset:0
    s_cmp_eq_u32 s93, 7
    v_mfma_f32_16x16x32_bf16 v[212:215], v[132:135], v[20:23], v[212:215]
    ds_read_b64_tr_b16 v[154:155], v7 offset:2048
    s_cselect_b32 s93, 0, s93
    v_mfma_f32_16x16x32_bf16 v[216:219], v[136:139], v[20:23], v[216:219]
    ds_read_b64_tr_b16 v[156:157], v8 offset:0
    v_mfma_f32_16x16x32_bf16 v[220:223], v[140:143], v[20:23], v[220:223]
    ds_read_b64_tr_b16 v[158:159], v8 offset:2048
    v_mfma_f32_16x16x32_bf16 v[224:227], v[128:131], v[24:27], v[224:227]
    buffer_load_dwordx4 v[64:67], v6, s[40:43], s54 offen sc1
    v_mfma_f32_16x16x32_bf16 v[228:231], v[132:135], v[24:27], v[228:231]
    v_mfma_f32_16x16x32_bf16 v[232:235], v[136:139], v[24:27], v[232:235]
    buffer_load_dwordx4 v[68:71], v14, s[40:43], s54 offen sc1
    v_mfma_f32_16x16x32_bf16 v[236:239], v[140:143], v[24:27], v[236:239]
    v_mfma_f32_16x16x32_bf16 v[240:243], v[128:131], v[28:31], v[240:243]
    buffer_load_dwordx4 v[72:75], v15, s[40:43], s54 offen sc1
    v_mfma_f32_16x16x32_bf16 v[244:247], v[132:135], v[28:31], v[244:247]
    v_mfma_f32_16x16x32_bf16 v[248:251], v[136:139], v[28:31], v[248:251]
    buffer_load_dwordx4 v[76:79], v4, s[40:43], s54 offen sc1
    v_mfma_f32_16x16x32_bf16 v[252:255], v[140:143], v[28:31], v[252:255]
    s_waitcnt vmcnt(16) lgkmcnt(0)
    v_mfma_f32_16x16x32_bf16 v[192:195], v[144:147], v[32:35], v[192:195]
    ds_read_b64_tr_b16 v[160:161], v2 offset:4096
    s_lshl_b32 s54, s93, 11
    v_mfma_f32_16x16x32_bf16 v[196:199], v[148:151], v[32:35], v[196:199]
    ds_read_b64_tr_b16 v[162:163], v2 offset:6144
    s_add_u32 s54, s54, 1024
    v_mfma_f32_16x16x32_bf16 v[200:203], v[152:155], v[32:35], v[200:203]
    ds_read_b64_tr_b16 v[164:165], v3 offset:4096
    s_add_u32 s54, s54, s50
    v_mfma_f32_16x16x32_bf16 v[204:207], v[156:159], v[32:35], v[204:207]
    ds_read_b64_tr_b16 v[166:167], v3 offset:6144
    s_add_u32 s93, s93, 1
    v_mfma_f32_16x16x32_bf16 v[208:211], v[144:147], v[36:39], v[208:211]
    ds_read_b64_tr_b16 v[168:169], v7 offset:4096
    s_cmp_eq_u32 s93, 7
    v_mfma_f32_16x16x32_bf16 v[212:215], v[148:151], v[36:39], v[212:215]
    ds_read_b64_tr_b16 v[170:171], v7 offset:6144
    s_cselect_b32 s93, 0, s93
    v_mfma_f32_16x16x32_bf16 v[216:219], v[152:155], v[36:39], v[216:219]
    ds_read_b64_tr_b16 v[172:173], v8 offset:4096
    v_mfma_f32_16x16x32_bf16 v[220:223], v[156:159], v[36:39], v[220:223]
    ds_read_b64_tr_b16 v[174:175], v8 offset:6144
    v_mfma_f32_16x16x32_bf16 v[224:227], v[144:147], v[40:43], v[224:227]
    buffer_load_dwordx4 v[16:19], v6, s[40:43], s55 offen sc1
    v_mfma_f32_16x16x32_bf16 v[228:231], v[148:151], v[40:43], v[228:231]
    v_mfma_f32_16x16x32_bf16 v[232:235], v[152:155], v[40:43], v[232:235]
    buffer_load_dwordx4 v[20:23], v14, s[40:43], s55 offen sc1
    v_mfma_f32_16x16x32_bf16 v[236:239], v[156:159], v[40:43], v[236:239]
    v_mfma_f32_16x16x32_bf16 v[240:243], v[144:147], v[44:47], v[240:243]
    buffer_load_dwordx4 v[24:27], v15, s[40:43], s55 offen sc1
    v_mfma_f32_16x16x32_bf16 v[244:247], v[148:151], v[44:47], v[244:247]
    v_mfma_f32_16x16x32_bf16 v[248:251], v[152:155], v[44:47], v[248:251]
    buffer_load_dwordx4 v[28:31], v4, s[40:43], s55 offen sc1
    v_mfma_f32_16x16x32_bf16 v[252:255], v[156:159], v[44:47], v[252:255]
    s_waitcnt vmcnt(12) lgkmcnt(0)
    v_mfma_f32_16x16x32_bf16 v[192:195], v[160:163], v[48:51], v[192:195]
    ds_read_b64_tr_b16 v[176:177], v2 offset:8192
    v_mfma_f32_16x16x32_bf16 v[196:199], v[164:167], v[48:51], v[196:199]
    ds_read_b64_tr_b16 v[178:179], v2 offset:10240
    v_mfma_f32_16x16x32_bf16 v[200:203], v[168:171], v[48:51], v[200:203]
    ds_read_b64_tr_b16 v[180:181], v3 offset:8192
    v_mfma_f32_16x16x32_bf16 v[204:207], v[172:175], v[48:51], v[204:207]
    ds_read_b64_tr_b16 v[182:183], v3 offset:10240
    v_mfma_f32_16x16x32_bf16 v[208:211], v[160:163], v[52:55], v[208:211]
    ds_read_b64_tr_b16 v[184:185], v7 offset:8192
    v_mfma_f32_16x16x32_bf16 v[212:215], v[164:167], v[52:55], v[212:215]
    ds_read_b64_tr_b16 v[186:187], v7 offset:10240
    v_mfma_f32_16x16x32_bf16 v[216:219], v[168:171], v[52:55], v[216:219]
    ds_read_b64_tr_b16 v[188:189], v8 offset:8192
    v_mfma_f32_16x16x32_bf16 v[220:223], v[172:175], v[52:55], v[220:223]
    ds_read_b64_tr_b16 v[190:191], v8 offset:10240
    v_mfma_f32_16x16x32_bf16 v[224:227], v[160:163], v[56:59], v[224:227]
    buffer_load_dwordx4 v[32:35], v6, s[40:43], s54 offen sc1
    v_mfma_f32_16x16x32_bf16 v[228:231], v[164:167], v[56:59], v[228:231]
    v_mfma_f32_16x16x32_bf16 v[232:235], v[168:171], v[56:59], v[232:235]
    buffer_load_dwordx4 v[36:39], v14, s[40:43], s54 offen sc1
    v_mfma_f32_16x16x32_bf16 v[236:239], v[172:175], v[56:59], v[236:239]
    v_mfma_f32_16x16x32_bf16 v[240:243], v[160:163], v[60:63], v[240:243]
    buffer_load_dwordx4 v[40:43], v15, s[40:43], s54 offen sc1
    v_mfma_f32_16x16x32_bf16 v[244:247], v[164:167], v[60:63], v[244:247]
    v_mfma_f32_16x16x32_bf16 v[248:251], v[168:171], v[60:63], v[248:251]
    buffer_load_dwordx4 v[44:47], v4, s[40:43], s54 offen sc1
    v_mfma_f32_16x16x32_bf16 v[252:255], v[172:175], v[60:63], v[252:255]
    s_waitcnt vmcnt(8) lgkmcnt(0)
    v_mfma_f32_16x16x32_bf16 v[192:195], v[176:179], v[64:67], v[192:195]
    ds_read_b64_tr_b16 v[96:97], v10 offset:0
    v_mfma_f32_16x16x32_bf16 v[196:199], v[180:183], v[64:67], v[196:199]
    ds_read_b64_tr_b16 v[98:99], v10 offset:2048
    v_mfma_f32_16x16x32_bf16 v[200:203], v[184:187], v[64:67], v[200:203]
    ds_read_b64_tr_b16 v[100:101], v11 offset:0
    v_mfma_f32_16x16x32_bf16 v[204:207], v[188:191], v[64:67], v[204:207]
    ds_read_b64_tr_b16 v[102:103], v11 offset:2048
    v_mfma_f32_16x16x32_bf16 v[208:211], v[176:179], v[68:71], v[208:211]
    ds_read_b64_tr_b16 v[104:105], v12 offset:0
    v_mfma_f32_16x16x32_bf16 v[212:215], v[180:183], v[68:71], v[212:215]
    ds_read_b64_tr_b16 v[106:107], v12 offset:2048
    v_mfma_f32_16x16x32_bf16 v[216:219], v[184:187], v[68:71], v[216:219]
    ds_read_b64_tr_b16 v[108:109], v13 offset:0
    v_mfma_f32_16x16x32_bf16 v[220:223], v[188:191], v[68:71], v[220:223]
    ds_read_b64_tr_b16 v[110:111], v13 offset:2048
    v_mfma_f32_16x16x32_bf16 v[224:227], v[176:179], v[72:75], v[224:227]
    v_mfma_f32_16x16x32_bf16 v[228:231], v[180:183], v[72:75], v[228:231]
    v_mfma_f32_16x16x32_bf16 v[232:235], v[184:187], v[72:75], v[232:235]
    v_mfma_f32_16x16x32_bf16 v[236:239], v[188:191], v[72:75], v[236:239]
    v_mfma_f32_16x16x32_bf16 v[240:243], v[176:179], v[76:79], v[240:243]
    v_mfma_f32_16x16x32_bf16 v[244:247], v[180:183], v[76:79], v[244:247]
    v_mfma_f32_16x16x32_bf16 v[248:251], v[184:187], v[76:79], v[248:251]
    v_mfma_f32_16x16x32_bf16 v[252:255], v[188:191], v[76:79], v[252:255]
    s_waitcnt vmcnt(4) lgkmcnt(0)
    v_mfma_f32_16x16x32_bf16 v[192:195], v[96:99], v[16:19], v[192:195]
    ds_read_b64_tr_b16 v[112:113], v10 offset:4096
    v_mfma_f32_16x16x32_bf16 v[196:199], v[100:103], v[16:19], v[196:199]
    ds_read_b64_tr_b16 v[114:115], v10 offset:6144
    v_mfma_f32_16x16x32_bf16 v[200:203], v[104:107], v[16:19], v[200:203]
    ds_read_b64_tr_b16 v[116:117], v11 offset:4096
    v_mfma_f32_16x16x32_bf16 v[204:207], v[108:111], v[16:19], v[204:207]
    ds_read_b64_tr_b16 v[118:119], v11 offset:6144
    v_mfma_f32_16x16x32_bf16 v[208:211], v[96:99], v[20:23], v[208:211]
    ds_read_b64_tr_b16 v[120:121], v12 offset:4096
    v_mfma_f32_16x16x32_bf16 v[212:215], v[100:103], v[20:23], v[212:215]
    ds_read_b64_tr_b16 v[122:123], v12 offset:6144
    v_mfma_f32_16x16x32_bf16 v[216:219], v[104:107], v[20:23], v[216:219]
    ds_read_b64_tr_b16 v[124:125], v13 offset:4096
    v_mfma_f32_16x16x32_bf16 v[220:223], v[108:111], v[20:23], v[220:223]
    ds_read_b64_tr_b16 v[126:127], v13 offset:6144
    v_mfma_f32_16x16x32_bf16 v[224:227], v[96:99], v[24:27], v[224:227]
    v_mfma_f32_16x16x32_bf16 v[228:231], v[100:103], v[24:27], v[228:231]
    v_mfma_f32_16x16x32_bf16 v[232:235], v[104:107], v[24:27], v[232:235]
    v_mfma_f32_16x16x32_bf16 v[236:239], v[108:111], v[24:27], v[236:239]
    v_mfma_f32_16x16x32_bf16 v[240:243], v[96:99], v[28:31], v[240:243]
    v_mfma_f32_16x16x32_bf16 v[244:247], v[100:103], v[28:31], v[244:247]
    v_mfma_f32_16x16x32_bf16 v[248:251], v[104:107], v[28:31], v[248:251]
    v_mfma_f32_16x16x32_bf16 v[252:255], v[108:111], v[28:31], v[252:255]
    v_lshrrev_b32 v5, 3, v0
    s_lshl_b32 s88, s80, 6
    v_add_u32 v5, s88, v5
    v_lshlrev_b32 v5, 10, v5
    v_and_b32 v9, 7, v0
    v_lshl_add_u32 v9, v9, 4, v5
    s_lshl_b32 s88, s7, 7
    v_add_u32 v9, s88, v9
    buffer_load_dwordx4 v[96:99], v9, s[36:39], 0 offen
    v_and_b32 v4, 15, v1
    v_mul_u32_u24 v4, 272, v4
    v_lshrrev_b32 v5, 4, v1
    v_lshl_add_u32 v4, v5, 4, v4
    v_add_u32 v4, s90, v4
    v_add_u32 v5, 98304, v4
    s_waitcnt vmcnt(1) lgkmcnt(0)
    v_mfma_f32_16x16x32_bf16 v[192:195], v[112:115], v[32:35], v[192:195]
    v_mfma_f32_16x16x32_bf16 v[196:199], v[116:119], v[32:35], v[196:199]
    v_mfma_f32_16x16x32_bf16 v[200:203], v[120:123], v[32:35], v[200:203]
    v_mfma_f32_16x16x32_bf16 v[204:207], v[124:127], v[32:35], v[204:207]
    v_mfma_f32_16x16x32_bf16 v[208:211], v[112:115], v[36:39], v[208:211]
    v_mfma_f32_16x16x32_bf16 v[212:215], v[116:119], v[36:39], v[212:215]
    v_mfma_f32_16x16x32_bf16 v[216:219], v[120:123], v[36:39], v[216:219]
    v_mfma_f32_16x16x32_bf16 v[220:223], v[124:127], v[36:39], v[220:223]
    v_mfma_f32_16x16x32_bf16 v[224:227], v[112:115], v[40:43], v[224:227]
    ds_write_b128 v4, v[192:195] offset:0
    v_mfma_f32_16x16x32_bf16 v[228:231], v[116:119], v[40:43], v[228:231]
    ds_write_b128 v4, v[196:199] offset:64
    v_mfma_f32_16x16x32_bf16 v[232:235], v[120:123], v[40:43], v[232:235]
    ds_write_b128 v4, v[200:203] offset:128
    v_mfma_f32_16x16x32_bf16 v[236:239], v[124:127], v[40:43], v[236:239]
    ds_write_b128 v4, v[204:207] offset:192
    v_mfma_f32_16x16x32_bf16 v[240:243], v[112:115], v[44:47], v[240:243]
    ds_write_b128 v4, v[208:211] offset:4352
    v_mfma_f32_16x16x32_bf16 v[244:247], v[116:119], v[44:47], v[244:247]
    ds_write_b128 v4, v[212:215] offset:4416
    v_mfma_f32_16x16x32_bf16 v[248:251], v[120:123], v[44:47], v[248:251]
    ds_write_b128 v4, v[216:219] offset:4480
    v_mfma_f32_16x16x32_bf16 v[252:255], v[124:127], v[44:47], v[252:255]
    ds_write_b128 v4, v[220:223] offset:4544
    ds_write_b128 v5, v[224:227] offset:0
    ds_write_b128 v5, v[228:231] offset:64
    ds_write_b128 v5, v[232:235] offset:128
    ds_write_b128 v5, v[236:239] offset:192
    ds_write_b128 v5, v[240:243] offset:4352
    ds_write_b128 v5, v[244:247] offset:4416
    ds_write_b128 v5, v[248:251] offset:4480
    ds_write_b128 v5, v[252:255] offset:4544
    s_waitcnt vmcnt(0) lgkmcnt(0)
    s_branch L_final
L_cspare:
    s_waitcnt lgkmcnt(0)
    s_barrier
    v_lshrrev_b32 v22, 3, v1
    s_lshl_b32 s86, s80, 6
    s_lshl_b32 s85, s3, 4
    s_add_u32 s86, s86, s85
    v_add_u32 v23, s86, v22
    v_lshlrev_b32 v23, 10, v23
    v_and_b32 v24, 7, v1
    v_lshl_add_u32 v26, v24, 4, v23
    s_mov_b32 s87, 8192
    buffer_load_dwordx4 v[32:35], v26, s[36:39], 0 offen offset:0
    buffer_load_dwordx4 v[36:39], v26, s[36:39], 0 offen offset:128
    buffer_load_dwordx4 v[40:43], v26, s[36:39], 0 offen offset:256
    buffer_load_dwordx4 v[44:47], v26, s[36:39], 0 offen offset:384
    buffer_load_dwordx4 v[48:51], v26, s[36:39], 0 offen offset:512
    buffer_load_dwordx4 v[52:55], v26, s[36:39], 0 offen offset:640
    buffer_load_dwordx4 v[56:59], v26, s[36:39], 0 offen offset:768
    buffer_load_dwordx4 v[60:63], v26, s[36:39], 0 offen offset:896
    buffer_load_dwordx4 v[64:67], v26, s[36:39], s87 offen offset:0
    buffer_load_dwordx4 v[68:71], v26, s[36:39], s87 offen offset:128
    buffer_load_dwordx4 v[72:75], v26, s[36:39], s87 offen offset:256
    buffer_load_dwordx4 v[76:79], v26, s[36:39], s87 offen offset:384
    buffer_load_dwordx4 v[80:83], v26, s[36:39], s87 offen offset:512
    buffer_load_dwordx4 v[84:87], v26, s[36:39], s87 offen offset:640
    buffer_load_dwordx4 v[88:91], v26, s[36:39], s87 offen offset:768
    buffer_load_dwordx4 v[92:95], v26, s[36:39], s87 offen offset:896
    buffer_load_dwordx2 v[12:13], off, s[72:75], 0 sc1
    s_mov_b32 s95, 0x3f803f80
    s_lshl_b32 s87, s34, 9
    s_lshl_b32 s85, s85, 3
    s_add_u32 s87, s87, s85
    s_add_u32 s87, s87, 160896
    v_lshlrev_b32 v28, 3, v22
    v_add_u32 v27, s87, v28
    s_lshl_b32 s86, s86, 3
    s_add_u32 s86, s86, 12845056
    s_mov_b32 s96, 0x01010101
    s_mov_b32 s97, 0x01010101
    v_mov_b32 v16, 0
    v_mov_b32 v17, 0
    v_mov_b32 v18, 0
    v_mov_b32 v19, 0
    s_waitcnt vmcnt(9)
    v_dot2c_f32_bf16 v16, s95, v32
    v_dot2c_f32_bf16 v18, v32, v32
    v_dot2c_f32_bf16 v17, s95, v33
    v_dot2c_f32_bf16 v19, v33, v33
    v_dot2c_f32_bf16 v16, s95, v34
    v_dot2c_f32_bf16 v18, v34, v34
    v_dot2c_f32_bf16 v17, s95, v35
    v_dot2c_f32_bf16 v19, v35, v35
    v_dot2c_f32_bf16 v16, s95, v36
    v_dot2c_f32_bf16 v18, v36, v36
    v_dot2c_f32_bf16 v17, s95, v37
    v_dot2c_f32_bf16 v19, v37, v37
    v_dot2c_f32_bf16 v16, s95, v38
    v_dot2c_f32_bf16 v18, v38, v38
    v_dot2c_f32_bf16 v17, s95, v39
    v_dot2c_f32_bf16 v19, v39, v39
    v_dot2c_f32_bf16 v16, s95, v40
    v_dot2c_f32_bf16 v18, v40, v40
    v_dot2c_f32_bf16 v17, s95, v41
    v_dot2c_f32_bf16 v19, v41, v41
    v_dot2c_f32_bf16 v16, s95, v42
    v_dot2c_f32_bf16 v18, v42, v42
    v_dot2c_f32_bf16 v17, s95, v43
    v_dot2c_f32_bf16 v19, v43, v43
    v_dot2c_f32_bf16 v16, s95, v44
    v_dot2c_f32_bf16 v18, v44, v44
    v_dot2c_f32_bf16 v17, s95, v45
    v_dot2c_f32_bf16 v19, v45, v45
    v_dot2c_f32_bf16 v16, s95, v46
    v_dot2c_f32_bf16 v18, v46, v46
    v_dot2c_f32_bf16 v17, s95, v47
    v_dot2c_f32_bf16 v19, v47, v47
    v_dot2c_f32_bf16 v16, s95, v48
    v_dot2c_f32_bf16 v18, v48, v48
    v_dot2c_f32_bf16 v17, s95, v49
    v_dot2c_f32_bf16 v19, v49, v49
    v_dot2c_f32_bf16 v16, s95, v50
    v_dot2c_f32_bf16 v18, v50, v50
    v_dot2c_f32_bf16 v17, s95, v51
    v_dot2c_f32_bf16 v19, v51, v51
    v_dot2c_f32_bf16 v16, s95, v52
    v_dot2c_f32_bf16 v18, v52, v52
    v_dot2c_f32_bf16 v17, s95, v53
    v_dot2c_f32_bf16 v19, v53, v53
    v_dot2c_f32_bf16 v16, s95, v54
    v_dot2c_f32_bf16 v18, v54, v54
    v_dot2c_f32_bf16 v17, s95, v55
    v_dot2c_f32_bf16 v19, v55, v55
    v_dot2c_f32_bf16 v16, s95, v56
    v_dot2c_f32_bf16 v18, v56, v56
    v_dot2c_f32_bf16 v17, s95, v57
    v_dot2c_f32_bf16 v19, v57, v57
    v_dot2c_f32_bf16 v16, s95, v58
    v_dot2c_f32_bf16 v18, v58, v58
    v_dot2c_f32_bf16 v17, s95, v59
    v_dot2c_f32_bf16 v19, v59, v59
    v_dot2c_f32_bf16 v16, s95, v60
    v_dot2c_f32_bf16 v18, v60, v60
    v_dot2c_f32_bf16 v17, s95, v61
    v_dot2c_f32_bf16 v19, v61, v61
    v_dot2c_f32_bf16 v16, s95, v62
    v_dot2c_f32_bf16 v18, v62, v62
    v_dot2c_f32_bf16 v17, s95, v63
    v_dot2c_f32_bf16 v19, v63, v63
    s_nop 2
    v_add_f32 v16, v16, v17
    v_add_f32 v18, v18, v19
    s_nop 0
    v_add_f32_dpp v16, v16, v16 quad_perm:[1,0,3,2] row_mask:0xf bank_mask:0xf
    s_nop 0
    v_add_f32_dpp v18, v18, v18 quad_perm:[1,0,3,2] row_mask:0xf bank_mask:0xf
    s_nop 0
    v_add_f32_dpp v16, v16, v16 quad_perm:[2,3,0,1] row_mask:0xf bank_mask:0xf
    s_nop 0
    v_add_f32_dpp v18, v18, v18 quad_perm:[2,3,0,1] row_mask:0xf bank_mask:0xf
    s_nop 0
    v_add_f32_dpp v16, v16, v16 row_half_mirror row_mask:0xf bank_mask:0xf
    s_nop 0
    v_add_f32_dpp v18, v18, v18 row_half_mirror row_mask:0xf bank_mask:0xf
    v_mul_f32 v20, 0x3b000000, v16
    v_mul_f32 v24, 0x3b000000, v18
    v_fma_f32 v24, -v20, v20, v24
    v_max_f32 v24, 0, v24
    v_add_f32 v24, 0x3727c5ac, v24
    v_rsq_f32 v21, v24
    s_mov_b64 exec, s[96:97]
    ds_write_b64 v27, v[20:21] offset:0
    buffer_store_dwordx2 v[20:21], v28, s[40:43], s86 offen offset:0 sc1
    s_mov_b64 exec, -1
    v_mov_b32 v16, 0
    v_mov_b32 v17, 0
    v_mov_b32 v18, 0
    v_mov_b32 v19, 0
    s_waitcnt vmcnt(2)
    v_dot2c_f32_bf16 v16, s95, v64
    v_dot2c_f32_bf16 v18, v64, v64
    v_dot2c_f32_bf16 v17, s95, v65
    v_dot2c_f32_bf16 v19, v65, v65
    v_dot2c_f32_bf16 v16, s95, v66
    v_dot2c_f32_bf16 v18, v66, v66
    v_dot2c_f32_bf16 v17, s95, v67
    v_dot2c_f32_bf16 v19, v67, v67
    v_dot2c_f32_bf16 v16, s95, v68
    v_dot2c_f32_bf16 v18, v68, v68
    v_dot2c_f32_bf16 v17, s95, v69
    v_dot2c_f32_bf16 v19, v69, v69
    v_dot2c_f32_bf16 v16, s95, v70
    v_dot2c_f32_bf16 v18, v70, v70
    v_dot2c_f32_bf16 v17, s95, v71
    v_dot2c_f32_bf16 v19, v71, v71
    v_dot2c_f32_bf16 v16, s95, v72
    v_dot2c_f32_bf16 v18, v72, v72
    v_dot2c_f32_bf16 v17, s95, v73
    v_dot2c_f32_bf16 v19, v73, v73
    v_dot2c_f32_bf16 v16, s95, v74
    v_dot2c_f32_bf16 v18, v74, v74
    v_dot2c_f32_bf16 v17, s95, v75
    v_dot2c_f32_bf16 v19, v75, v75
    v_dot2c_f32_bf16 v16, s95, v76
    v_dot2c_f32_bf16 v18, v76, v76
    v_dot2c_f32_bf16 v17, s95, v77
    v_dot2c_f32_bf16 v19, v77, v77
    v_dot2c_f32_bf16 v16, s95, v78
    v_dot2c_f32_bf16 v18, v78, v78
    v_dot2c_f32_bf16 v17, s95, v79
    v_dot2c_f32_bf16 v19, v79, v79
    v_dot2c_f32_bf16 v16, s95, v80
    v_dot2c_f32_bf16 v18, v80, v80
    v_dot2c_f32_bf16 v17, s95, v81
    v_dot2c_f32_bf16 v19, v81, v81
    v_dot2c_f32_bf16 v16, s95, v82
    v_dot2c_f32_bf16 v18, v82, v82
    v_dot2c_f32_bf16 v17, s95, v83
    v_dot2c_f32_bf16 v19, v83, v83
    v_dot2c_f32_bf16 v16, s95, v84
    v_dot2c_f32_bf16 v18, v84, v84
    v_dot2c_f32_bf16 v17, s95, v85
    v_dot2c_f32_bf16 v19, v85, v85
    v_dot2c_f32_bf16 v16, s95, v86
    v_dot2c_f32_bf16 v18, v86, v86
    v_dot2c_f32_bf16 v17, s95, v87
    v_dot2c_f32_bf16 v19, v87, v87
    v_dot2c_f32_bf16 v16, s95, v88
    v_dot2c_f32_bf16 v18, v88, v88
    v_dot2c_f32_bf16 v17, s95, v89
    v_dot2c_f32_bf16 v19, v89, v89
    v_dot2c_f32_bf16 v16, s95, v90
    v_dot2c_f32_bf16 v18, v90, v90
    v_dot2c_f32_bf16 v17, s95, v91
    v_dot2c_f32_bf16 v19, v91, v91
    v_dot2c_f32_bf16 v16, s95, v92
    v_dot2c_f32_bf16 v18, v92, v92
    v_dot2c_f32_bf16 v17, s95, v93
    v_dot2c_f32_bf16 v19, v93, v93
    v_dot2c_f32_bf16 v16, s95, v94
    v_dot2c_f32_bf16 v18, v94, v94
    v_dot2c_f32_bf16 v17, s95, v95
    v_dot2c_f32_bf16 v19, v95, v95
    s_nop 2
    v_add_f32 v16, v16, v17
    v_add_f32 v18, v18, v19
    s_nop 0
    v_add_f32_dpp v16, v16, v16 quad_perm:[1,0,3,2] row_mask:0xf bank_mask:0xf
    s_nop 0
    v_add_f32_dpp v18, v18, v18 quad_perm:[1,0,3,2] row_mask:0xf bank_mask:0xf
    s_nop 0
    v_add_f32_dpp v16, v16, v16 quad_perm:[2,3,0,1] row_mask:0xf bank_mask:0xf
    s_nop 0
    v_add_f32_dpp v18, v18, v18 quad_perm:[2,3,0,1] row_mask:0xf bank_mask:0xf
    s_nop 0
    v_add_f32_dpp v16, v16, v16 row_half_mirror row_mask:0xf bank_mask:0xf
    s_nop 0
    v_add_f32_dpp v18, v18, v18 row_half_mirror row_mask:0xf bank_mask:0xf
    v_mul_f32 v30, 0x3b000000, v16
    v_mul_f32 v24, 0x3b000000, v18
    v_fma_f32 v24, -v30, v30, v24
    v_max_f32 v24, 0, v24
    v_add_f32 v24, 0x3727c5ac, v24
    v_rsq_f32 v31, v24
    s_mov_b64 exec, s[96:97]
    ds_write_b64 v27, v[30:31] offset:64
    buffer_store_dwordx2 v[30:31], v28, s[40:43], s86 offen offset:64 sc1
    s_mov_b64 exec, -1
    s_lshl_b32 s85, s80, 2
    s_add_u32 s85, s85, s3
    s_lshl_b32 s85, s85, 3
    s_add_u32 s85, s85, 12894208
    s_waitcnt vmcnt(0) lgkmcnt(0)
    s_mov_b32 s33, 262144
L_nagain_24:
    v_cmp_gt_i32 vcc, 0, v13
    s_cbranch_vccnz L_nok_23
    buffer_load_dwordx2 v[12:13], off, s[72:75], 0 sc1
    s_sub_u32 s33, s33, 1
    s_waitcnt vmcnt(0)
    s_cbranch_scc0 L_nagain_24
L_nok_23:
    v_readfirstlane_b32 s82, v12
    v_readfirstlane_b32 s83, v13
    v_mov_b32 v22, 162996
    v_mov_b32 v23, 1
    s_mov_b64 exec, 1
    ds_add_u32 v22, v23
    s_mov_b64 exec, -1
    v_mov_b32 v14, s82
    v_mov_b32 v15, s83
    s_mov_b64 exec, 1
    buffer_store_dwordx2 v[14:15], off, s[40:43], s85 sc1
    s_mov_b64 exec, -1
    s_mov_b32 s70, 2097152
    s_lshl_b32 s88, s4, 18
    s_and_b32 s89, s6, 3
    s_lshl_b32 s89, s89, 16
    s_add_u32 s88, s88, s89
    s_lshl_b32 s89, s3, 14
    s_add_u32 s88, s88, s89
    v_lshlrev_b32 v29, 7, v1
    buffer_load_dword v25, v29, s[68:71], s88 offen
    s_add_u32 s88, s88, 8192
    buffer_load_dword v25, v29, s[68:71], s88 offen
    s_lshl_b32 s88, s4, 2
    s_and_b32 s89, s6, 3
    s_add_u32 s88, s88, s89
    s_mul_i32 s88, s88, 57344
    s_mul_i32 s89, s3, 14336
    s_add_u32 s88, s88, s89
    v_lshlrev_b32 v29, 7, v1
    buffer_load_dword v25, v29, s[28:31], s88 offen
    s_add_u32 s88, s88, 8192
    s_mov_b32 exec_hi, 0xffff
    buffer_load_dword v25, v29, s[28:31], s88 offen
    s_mov_b32 exec_hi, -1
    v_mov_b32 v22, 162996
L_lagain_26:
    ds_read_b32 v23, v22
    s_waitcnt lgkmcnt(0)
    v_cmp_eq_u32 vcc, 4, v23
    s_cbranch_vccnz L_lok_25
    s_sleep 1
    s_branch L_lagain_26
L_lok_25:
    v_mov_b32 v22, 162956
    v_mov_b32 v23, 1
    s_mov_b64 exec, 1
    ds_add_u32 v22, v23
    s_mov_b64 exec, -1
    s_branch L_cE
L_lspare:
    s_waitcnt lgkmcnt(0)
    v_lshrrev_b32 v4, 3, v1
    s_lshl_b32 s85, s5, 6
    s_lshl_b32 s86, s81, 4
    s_add_u32 s85, s85, s86
    v_and_b32 v5, 7, v1
    v_lshlrev_b32 v5, 4, v5
    s_lshl_b32 s86, s4, 7
    v_add_u32 v5, s86, v5
    s_sub_u32 s85, s85, 3
    v_lshl_add_u32 v4, v4, 1, s85
    v_lshl_add_u32 v4, v4, 10, v5
    buffer_load_dwordx4 v[48:51], v4, s[56:59], 0 offen
    v_add_u32 v4, 1024, v4
    buffer_load_dwordx4 v[52:55], v4, s[56:59], 0 offen
    v_add_u32 v4, 1024, v4
    buffer_load_dwordx4 v[56:59], v4, s[56:59], 0 offen
    v_add_u32 v4, 1024, v4
    buffer_load_dwordx4 v[60:63], v4, s[56:59], 0 offen
    buffer_load_dwordx4 v[68:71], v4, s[60:63], 0 offen
    v_add_u32 v4, 1024, v4
    buffer_load_dwordx4 v[64:67], v4, s[56:59], 0 offen
    buffer_load_dwordx4 v[72:75], v4, s[60:63], 0 offen
    s_mov_b32 m0, 159872
    v_lshlrev_b32 v4, 4, v1
    s_lshl_b32 s85, s4, 9
    s_mov_b32 exec_hi, 0
    buffer_load_dwordx4 v4, s[64:67], s85 offen lds
    s_mov_b32 exec_hi, -1
    s_load_dwordx2 s[40:41], s[0:1], 96
    s_load_dwordx2 s[68:69], s[0:1], 32
    s_load_dwordx2 s[96:97], s[0:1], 40
    s_load_dwordx2 s[28:29], s[0:1], 72
    s_load_dwordx2 s[44:45], s[0:1], 80
    s_mov_b32 s42, 16777216
    s_mov_b32 s43, 0x20000
    s_mov_b32 s70, 4096
    s_mov_b32 s71, 0x20000
    s_mov_b32 s30, 1835008
    s_mov_b32 s31, 0x20000
    s_mov_b32 s46, 2097152
    s_mov_b32 s47, 0x20000
    s_mov_b32 s74, 256
    s_mov_b32 s75, 0x20000
    s_lshl_b32 s80, s6, 1
    s_add_u32 s80, s80, s34
    s_lshl_b32 s87, s79, 1
    s_add_u32 s32, s7, s87
    s_add_u32 s32, s32, s4
    s_cmp_ge_u32 s32, 7
    s_cselect_b32 s87, 7, 0
    s_sub_u32 s32, s32, s87
    s_cmp_ge_u32 s32, 7
    s_cselect_b32 s87, 7, 0
    s_sub_u32 s32, s32, s87
    v_lshrrev_b32 v4, 3, v1
    v_bfe_u32 v5, v1, 4, 2
    v_lshlrev_b32 v5, 1, v5
    v_and_b32 v6, 7, v1
    v_xor_b32 v5, v5, v6
    v_lshlrev_b32 v4, 10, v4
    v_lshl_add_u32 v15, v5, 4, v4
    s_mul_i32 s85, s81, 458752
    s_lshl_b32 s86, s7, 7
    s_add_u32 s85, s85, s86
    v_add_u32 v15, s85, v15
    s_mul_i32 s90, s81, 12288
    s_lshl_b32 s94, s4, 5
    s_add_u32 s94, s94, s5
    s_lshl_b32 s87, s94, 2
    s_lshl_b32 s94, s94, 1
    s_lshl_b32 s88, s94, 12
    s_waitcnt lgkmcnt(0)
    s_load_dword s84, s[96:97], s87
    s_add_u32 s68, s68, s88
    s_addc_u32 s69, s69, 0
    s_barrier
    buffer_load_dwordx2 v[192:193], off, s[72:75], 0 sc1
    s_lshr_b32 s85, s81, 1
    s_add_u32 s94, s94, s85
    s_lshl_b32 s85, s85, 12
    s_add_u32 s68, s68, s85
    s_addc_u32 s69, s69, 0
    s_and_b32 s85, s81, 1
    s_lshl_b32 s85, s85, 11
    v_lshl_add_u32 v190, v1, 4, s85
    buffer_load_dwordx4 v[148:151], v190, s[68:71], 0 offen offset:0
    buffer_load_dwordx4 v[152:155], v190, s[68:71], 0 offen offset:4
    buffer_load_dwordx4 v[156:159], v190, s[68:71], 0 offen offset:8
    buffer_load_dwordx4 v[160:163], v190, s[68:71], 0 offen offset:1024
    buffer_load_dwordx4 v[164:167], v190, s[68:71], 0 offen offset:1028
    buffer_load_dwordx4 v[168:171], v190, s[68:71], 0 offen offset:1032
    s_waitcnt vmcnt(7)
    v_and_b32 v5, 7, v1
    v_lshlrev_b32 v4, 6, v5
    v_add_u32 v6, 159872, v4
    ds_read_b128 v[76:79], v6 offset:0
    ds_read_b128 v[80:83], v6 offset:16
    ds_read_b128 v[84:87], v6 offset:32
    ds_read_b128 v[88:91], v6 offset:48
    v_mul_u32_u24 v26, 1040, v5
    v_lshrrev_b32 v4, 3, v1
    s_lshl_b32 s85, s81, 5
    s_sub_u32 s85, 147580, s85
    v_lshlrev_b32 v4, 2, v4
    v_sub_u32 v26, v26, v4
    v_add_u32 v26, s85, v26
    s_waitcnt lgkmcnt(0)
    v_lshlrev_b32 v92, 16, v76
    v_and_b32 v100, 0xffff0000, v76
    v_lshlrev_b32 v108, 16, v77
    v_and_b32 v116, 0xffff0000, v77
    v_lshlrev_b32 v93, 16, v78
    v_and_b32 v101, 0xffff0000, v78
    v_lshlrev_b32 v109, 16, v79
    v_and_b32 v117, 0xffff0000, v79
    v_lshlrev_b32 v94, 16, v80
    v_and_b32 v102, 0xffff0000, v80
    v_lshlrev_b32 v110, 16, v81
    v_and_b32 v118, 0xffff0000, v81
    v_lshlrev_b32 v95, 16, v82
    v_and_b32 v103, 0xffff0000, v82
    v_lshlrev_b32 v111, 16, v83
    v_and_b32 v119, 0xffff0000, v83
    v_lshlrev_b32 v96, 16, v84
    v_and_b32 v104, 0xffff0000, v84
    v_lshlrev_b32 v112, 16, v85
    v_and_b32 v120, 0xffff0000, v85
    v_lshlrev_b32 v97, 16, v86
    v_and_b32 v105, 0xffff0000, v86
    v_lshlrev_b32 v113, 16, v87
    v_and_b32 v121, 0xffff0000, v87
    v_lshlrev_b32 v98, 16, v88
    v_and_b32 v106, 0xffff0000, v88
    v_lshlrev_b32 v114, 16, v89
    v_and_b32 v122, 0xffff0000, v89
    v_lshlrev_b32 v99, 16, v90
    v_and_b32 v107, 0xffff0000, v90
    v_lshlrev_b32 v115, 16, v91
    v_and_b32 v123, 0xffff0000, v91
    v_lshlrev_b32 v124, 16, v48
    v_and_b32 v125, 0xffff0000, v48
    v_lshlrev_b32 v126, 16, v49
    v_and_b32 v127, 0xffff0000, v49
    v_lshlrev_b32 v128, 16, v50
    v_and_b32 v129, 0xffff0000, v50
    v_lshlrev_b32 v130, 16, v51
    v_and_b32 v131, 0xffff0000, v51
    v_pk_mul_f32 v[132:133], v[124:125], v[116:117]
    v_pk_mul_f32 v[134:135], v[126:127], v[118:119]
    v_pk_mul_f32 v[136:137], v[128:129], v[120:121]
    v_pk_mul_f32 v[138:139], v[130:131], v[122:123]
    v_lshlrev_b32 v124, 16, v52
    v_and_b32 v125, 0xffff0000, v52
    v_lshlrev_b32 v126, 16, v53
    v_and_b32 v127, 0xffff0000, v53
    v_lshlrev_b32 v128, 16, v54
    v_and_b32 v129, 0xffff0000, v54
    v_lshlrev_b32 v130, 16, v55
    v_and_b32 v131, 0xffff0000, v55
    v_pk_fma_f32 v[132:133], v[124:125], v[108:109], v[132:133]
    v_pk_fma_f32 v[134:135], v[126:127], v[110:111], v[134:135]
    v_pk_fma_f32 v[136:137], v[128:129], v[112:113], v[136:137]
    v_pk_fma_f32 v[138:139], v[130:131], v[114:115], v[138:139]
    v_pk_mul_f32 v[140:141], v[124:125], v[116:117]
    v_pk_mul_f32 v[142:143], v[126:127], v[118:119]
    v_pk_mul_f32 v[144:145], v[128:129], v[120:121]
    v_pk_mul_f32 v[146:147], v[130:131], v[122:123]
    v_lshlrev_b32 v124, 16, v56
    v_and_b32 v125, 0xffff0000, v56
    v_lshlrev_b32 v126, 16, v57
    v_and_b32 v127, 0xffff0000, v57
    v_lshlrev_b32 v128, 16, v58
    v_and_b32 v129, 0xffff0000, v58
    v_lshlrev_b32 v130, 16, v59
    v_and_b32 v131, 0xffff0000, v59
    v_pk_fma_f32 v[132:133], v[124:125], v[100:101], v[132:133]
    v_pk_fma_f32 v[134:135], v[126:127], v[102:103], v[134:135]
    v_pk_fma_f32 v[136:137], v[128:129], v[104:105], v[136:137]
    v_pk_fma_f32 v[138:139], v[130:131], v[106:107], v[138:139]
    v_pk_fma_f32 v[140:141], v[124:125], v[108:109], v[140:141]
    v_pk_fma_f32 v[142:143], v[126:127], v[110:111], v[142:143]
    v_pk_fma_f32 v[144:145], v[128:129], v[112:113], v[144:145]
    v_pk_fma_f32 v[146:147], v[130:131], v[114:115], v[146:147]
    v_lshlrev_b32 v124, 16, v60
    v_and_b32 v125, 0xffff0000, v60
    v_lshlrev_b32 v126, 16, v61
    v_and_b32 v127, 0xffff0000, v61
    v_lshlrev_b32 v128, 16, v62
    v_and_b32 v129, 0xffff0000, v62
    v_lshlrev_b32 v130, 16, v63
    v_and_b32 v131, 0xffff0000, v63
    v_pk_fma_f32 v[132:133], v[124:125], v[92:93], v[132:133]
    v_pk_fma_f32 v[134:135], v[126:127], v[94:95], v[134:135]
    v_pk_fma_f32 v[136:137], v[128:129], v[96:97], v[136:137]
    v_pk_fma_f32 v[138:139], v[130:131], v[98:99], v[138:139]
    v_pk_fma_f32 v[140:141], v[124:125], v[100:101], v[140:141]
    v_pk_fma_f32 v[142:143], v[126:127], v[102:103], v[142:143]
    v_pk_fma_f32 v[144:145], v[128:129], v[104:105], v[144:145]
    v_pk_fma_f32 v[146:147], v[130:131], v[106:107], v[146:147]
    v_lshlrev_b32 v124, 16, v64
    v_and_b32 v125, 0xffff0000, v64
    v_lshlrev_b32 v126, 16, v65
    v_and_b32 v127, 0xffff0000, v65
    v_lshlrev_b32 v128, 16, v66
    v_and_b32 v129, 0xffff0000, v66
    v_lshlrev_b32 v130, 16, v67
    v_and_b32 v131, 0xffff0000, v67
    v_pk_fma_f32 v[140:141], v[124:125], v[92:93], v[140:141]
    v_pk_fma_f32 v[142:143], v[126:127], v[94:95], v[142:143]
    v_pk_fma_f32 v[144:145], v[128:129], v[96:97], v[144:145]
    v_pk_fma_f32 v[146:147], v[130:131], v[98:99], v[146:147]
    v_lshlrev_b32 v124, 16, v68
    v_and_b32 v125, 0xffff0000, v68
    v_lshlrev_b32 v126, 16, v69
    v_and_b32 v127, 0xffff0000, v69
    v_lshlrev_b32 v128, 16, v70
    v_and_b32 v129, 0xffff0000, v70
    v_lshlrev_b32 v130, 16, v71
    v_and_b32 v131, 0xffff0000, v71
    v_pk_mul_f32 v[132:133], v[132:133], v[124:125]
    v_pk_mul_f32 v[134:135], v[134:135], v[126:127]
    v_pk_mul_f32 v[136:137], v[136:137], v[128:129]
    v_pk_mul_f32 v[138:139], v[138:139], v[130:131]
    v_lshlrev_b32 v124, 16, v72
    v_and_b32 v125, 0xffff0000, v72
    v_lshlrev_b32 v126, 16, v73
    v_and_b32 v127, 0xffff0000, v73
    v_lshlrev_b32 v128, 16, v74
    v_and_b32 v129, 0xffff0000, v74
    v_lshlrev_b32 v130, 16, v75
    v_and_b32 v131, 0xffff0000, v75
    v_pk_mul_f32 v[140:141], v[140:141], v[124:125]
    v_pk_mul_f32 v[142:143], v[142:143], v[126:127]
    v_pk_mul_f32 v[144:145], v[144:145], v[128:129]
    v_pk_mul_f32 v[146:147], v[146:147], v[130:131]
    v_cvt_pk_bf16_f32 v124, v140, v132
    v_cvt_pk_bf16_f32 v125, v141, v133
    v_cvt_pk_bf16_f32 v126, v142, v134
    v_cvt_pk_bf16_f32 v127, v143, v135
    v_cvt_pk_bf16_f32 v128, v144, v136
    v_cvt_pk_bf16_f32 v129, v145, v137
    v_cvt_pk_bf16_f32 v130, v146, v138
    v_cvt_pk_bf16_f32 v131, v147, v139
    ds_write_b32 v26, v124 offset:0
    ds_write_b32 v26, v125 offset:128
    ds_write_b32 v26, v126 offset:256
    ds_write_b32 v26, v127 offset:384
    ds_write_b32 v26, v128 offset:512
    ds_write_b32 v26, v129 offset:640
    ds_write_b32 v26, v130 offset:768
    ds_write_b32 v26, v131 offset:896
    s_waitcnt lgkmcnt(0)
    v_mov_b32 v4, 162988
    v_mov_b32 v5, 1
    s_mov_b64 exec, 1
    ds_add_u32 v4, v5
    s_mov_b64 exec, -1
    v_mov_b32 v4, 162988
L_lagain_28:
    ds_read_b32 v5, v4
    s_waitcnt lgkmcnt(0)
    v_cmp_eq_u32 vcc, 4, v5
    s_cbranch_vccnz L_lok_27
    s_sleep 1
    s_branch L_lagain_28
L_lok_27:
    s_mul_i32 s85, s81, 2080
    s_add_u32 s85, s85, 147456
    v_lshl_add_u32 v4, v1, 4, s85
    ds_read_b128 v[48:51], v4
    ds_read_b128 v[52:55], v4 offset:1040
    v_lshrrev_b32 v4, 3, v1
    v_lshlrev_b32 v4, 12, v4
    v_and_b32 v5, 7, v1
    v_lshl_add_u32 v4, v5, 4, v4
    s_lshl_b32 s85, s4, 18
    s_lshl_b32 s86, s81, 16
    s_add_u32 s85, s85, s86
    s_lshl_b32 s86, s5, 7
    s_sub_u32 s86, 3968, s86
    s_add_u32 s85, s85, s86
    s_add_u32 s86, s85, 32768
    s_waitcnt lgkmcnt(0)
    buffer_store_dwordx4 v[48:51], v4, s[40:43], s85 offen sc1
    buffer_store_dwordx4 v[52:55], v4, s[40:43], s86 offen sc1
    s_waitcnt vmcnt(2)
    v_alignbit_b32 v172, v152, v148, 16
    v_alignbit_b32 v176, v156, v152, 16
    v_alignbit_b32 v173, v153, v149, 16
    v_alignbit_b32 v177, v157, v153, 16
    v_alignbit_b32 v174, v154, v150, 16
    v_alignbit_b32 v178, v158, v154, 16
    v_alignbit_b32 v175, v155, v151, 16
    v_alignbit_b32 v179, v159, v155, 16
    v_alignbit_b32 v180, v164, v160, 16
    v_alignbit_b32 v184, v168, v164, 16
    v_alignbit_b32 v181, v165, v161, 16
    v_alignbit_b32 v185, v169, v165, 16
    v_alignbit_b32 v182, v166, v162, 16
    v_alignbit_b32 v186, v170, v166, 16
    v_alignbit_b32 v183, v167, v163, 16
    v_alignbit_b32 v187, v171, v167, 16
    s_lshr_b32 s85, s81, 1
    s_mul_i32 s86, s85, 16640
    s_add_u32 s86, s86, 49184
    v_add_u32 v4, s86, v190
    ds_write_b128 v4, v[148:151] offset:0
    ds_write_b128 v4, v[172:175] offset:4160
    ds_write_b128 v4, v[152:155] offset:8320
    ds_write_b128 v4, v[176:179] offset:12480
    ds_write_b128 v4, v[160:163] offset:1024
    ds_write_b128 v4, v[180:183] offset:5184
    ds_write_b128 v4, v[164:167] offset:9344
    ds_write_b128 v4, v[184:187] offset:13504
    v_mov_b32 v76, 0
    v_mov_b32 v77, 0
    v_mov_b32 v78, 0
    v_mov_b32 v79, 0
    s_mul_i32 s86, s85, 4608
    s_add_u32 s86, s86, 86528
    v_and_b32 v5, 31, v1
    v_lshl_add_u32 v5, v5, 4, s86
    ds_write_b128 v5, v[76:79]
    s_bitcmp1_b32 s81, 0
    s_cbranch_scc1 L_hf_29
    v_mov_b32 v80, 0
    v_mov_b32 v81, 0
    v_mov_b32 v82, 0
    v_mov_b32 v83, 0
    v_mov_b32 v84, 0
    v_mov_b32 v85, 0
    v_mov_b32 v86, 0
    v_mov_b32 v87, 0
    v_mov_b32 v88, 0
    v_mov_b32 v89, 0
    v_mov_b32 v90, 0
    v_mov_b32 v91, 0
    v_lshlrev_b32 v83, 16, v148
    v_mov_b32 v87, v148
    v_lshlrev_b32 v90, 16, v148
    v_mov_b32 v91, v172
    v_subrev_u32 v4, 32, v4
    s_mov_b64 exec, 1
    ds_write_b128 v4, v[76:79] offset:0
    ds_write_b128 v4, v[76:79] offset:16
    ds_write_b128 v4, v[76:79] offset:4160
    ds_write_b128 v4, v[80:83] offset:4176
    ds_write_b128 v4, v[76:79] offset:8320
    ds_write_b128 v4, v[84:87] offset:8336
    ds_write_b128 v4, v[76:79] offset:12480
    ds_write_b128 v4, v[88:91] offset:12496
    s_mov_b64 exec, -1
L_hf_29:
    s_mov_b32 s33, 262144
L_nagain_31:
    v_cmp_gt_i32 vcc, 0, v193
    s_cbranch_vccnz L_nok_30
    buffer_load_dwordx2 v[192:193], off, s[72:75], 0 sc1
    s_sub_u32 s33, s33, 1
    s_waitcnt vmcnt(0)
    s_cbranch_scc0 L_nagain_31
L_nok_30:
    v_readfirstlane_b32 s82, v192
    v_readfirstlane_b32 s83, v193
    s_waitcnt vmcnt(0)
    v_mov_b32 v4, 162992
    v_mov_b32 v5, 1
    s_mov_b64 exec, 1
    ds_add_u32 v4, v5
    s_mov_b64 exec, -1
    v_mov_b32 v4, 162992
L_lagain_33:
    ds_read_b32 v5, v4
    s_waitcnt lgkmcnt(0)
    v_cmp_eq_u32 vcc, 4, v5
    s_cbranch_vccnz L_lok_32
    s_sleep 1
    s_branch L_lagain_33
L_lok_32:
    s_lshl_b32 s85, s4, 2
    s_add_u32 s85, s85, s81
    s_lshl_b32 s85, s85, 5
    s_add_u32 s85, s85, s5
    s_lshl_b32 s85, s85, 2
    s_add_u32 s85, s85, 12861440
    v_mov_b32 v188, s82
    s_mov_b64 exec, 1
    buffer_store_dword v188, off, s[40:43], s85 sc1
    s_mov_b64 exec, -1
    s_mov_b32 s92, s32
    s_lshl_b32 s86, s92, 16
    s_add_u32 m0, s90, 98304
    s_add_u32 s92, s92, 1
    s_cmp_eq_u32 s92, 7
    s_cselect_b32 s92, 0, s92
    buffer_load_dwordx4 v15, s[28:31], s86 offen  lds
    s_add_u32 m0, s90, 99328
    s_add_u32 s86, s86, 8192
    buffer_load_dwordx4 v15, s[28:31], s86 offen  lds
    s_add_u32 m0, s90, 100352
    s_add_u32 s86, s86, 8192
    buffer_load_dwordx4 v15, s[28:31], s86 offen  lds
    s_add_u32 m0, s90, 101376
    s_add_u32 s86, s86, 8192
    buffer_load_dwordx4 v15, s[28:31], s86 offen  lds
    s_lshl_b32 s86, s92, 16
    s_add_u32 m0, s90, 102400
    s_add_u32 s92, s92, 1
    s_cmp_eq_u32 s92, 7
    s_cselect_b32 s92, 0, s92
    buffer_load_dwordx4 v15, s[28:31], s86 offen  lds
    s_add_u32 m0, s90, 103424
    s_add_u32 s86, s86, 8192
    buffer_load_dwordx4 v15, s[28:31], s86 offen  lds
    s_add_u32 m0, s90, 104448
    s_add_u32 s86, s86, 8192
    buffer_load_dwordx4 v15, s[28:31], s86 offen  lds
    s_add_u32 m0, s90, 105472
    s_add_u32 s86, s86, 8192
    buffer_load_dwordx4 v15, s[28:31], s86 offen  lds
    s_lshl_b32 s86, s92, 16
    s_add_u32 m0, s90, 106496
    s_add_u32 s92, s92, 1
    s_cmp_eq_u32 s92, 7
    s_cselect_b32 s92, 0, s92
    buffer_load_dwordx4 v15, s[28:31], s86 offen  lds
    s_add_u32 m0, s90, 107520
    s_add_u32 s86, s86, 8192
    buffer_load_dwordx4 v15, s[28:31], s86 offen  lds
    s_add_u32 m0, s90, 108544
    s_add_u32 s86, s86, 8192
    buffer_load_dwordx4 v15, s[28:31], s86 offen  lds
    s_add_u32 m0, s90, 109568
    s_add_u32 s86, s86, 8192
    buffer_load_dwordx4 v15, s[28:31], s86 offen  lds
    s_lshl_b32 s86, s92, 16
    s_add_u32 m0, s90, 0
    s_add_u32 s92, s92, 1
    s_cmp_eq_u32 s92, 7
    s_cselect_b32 s92, 0, s92
    buffer_load_dwordx4 v15, s[28:31], s86 offen  lds
    s_add_u32 m0, s90, 1024
    s_add_u32 s86, s86, 8192
    buffer_load_dwordx4 v15, s[28:31], s86 offen  lds
    s_add_u32 m0, s90, 2048
    s_add_u32 s86, s86, 8192
    buffer_load_dwordx4 v15, s[28:31], s86 offen  lds
    s_add_u32 m0, s90, 3072
    s_add_u32 s86, s86, 8192
    buffer_load_dwordx4 v15, s[28:31], s86 offen  lds
    s_lshl_b32 s86, s92, 16
    s_add_u32 m0, s90, 4096
    s_add_u32 s92, s92, 1
    s_cmp_eq_u32 s92, 7
    s_cselect_b32 s92, 0, s92
    buffer_load_dwordx4 v15, s[28:31], s86 offen  lds
    s_add_u32 m0, s90, 5120
    s_add_u32 s86, s86, 8192
    buffer_load_dwordx4 v15, s[28:31], s86 offen  lds
    s_add_u32 m0, s90, 6144
    s_add_u32 s86, s86, 8192
    buffer_load_dwordx4 v15, s[28:31], s86 offen  lds
    s_add_u32 m0, s90, 7168
    s_add_u32 s86, s86, 8192
    buffer_load_dwordx4 v15, s[28:31], s86 offen  lds
    s_lshl_b32 s86, s92, 16
    s_add_u32 m0, s90, 8192
    s_add_u32 s92, s92, 1
    s_cmp_eq_u32 s92, 7
    s_cselect_b32 s92, 0, s92
    buffer_load_dwordx4 v15, s[28:31], s86 offen  lds
    s_add_u32 m0, s90, 9216
    s_add_u32 s86, s86, 8192
    buffer_load_dwordx4 v15, s[28:31], s86 offen  lds
    s_add_u32 m0, s90, 10240
    s_add_u32 s86, s86, 8192
    buffer_load_dwordx4 v15, s[28:31], s86 offen  lds
    s_add_u32 m0, s90, 11264
    s_add_u32 s86, s86, 8192
    buffer_load_dwordx4 v15, s[28:31], s86 offen  lds
    s_lshr_b32 s85, s81, 1
    s_mul_i32 s86, s85, 4608
    s_add_u32 s86, s86, 82432
    v_lshl_add_u32 v14, v1, 4, s86
    v_and_b32 v5, 15, v1
    v_lshrrev_b32 v6, 4, v1
    v_lshlrev_b32 v7, 1, v5
    v_sub_u32 v7, v6, v7
    v_add_u32 v7, 30, v7
    v_lshl_add_u32 v11, v7, 4, s86
    v_lshlrev_b32 v7, 2, v5
    v_add_u32 v7, v7, v6
    v_lshlrev_b32 v13, 3, v7
    s_and_b32 s33, s81, 1
    s_lshl_b32 s93, s33, 11
    s_sub_u32 s86, s86, s93
    s_add_u32 s86, s86, 2552
    v_sub_u32 v12, s86, v13
    v_add_u32 v5, 1, v5
    v_and_b32 v7, 3, v5
    v_sub_u32 v5, v5, v7
    v_lshl_add_u32 v5, v6, 3, v5
    v_lshlrev_b32 v5, 1, v5
    v_mul_u32_u24 v7, 4160, v7
    s_mul_i32 s86, s85, 16640
    s_lshl_b32 s93, s33, 8
    s_add_u32 s86, s86, s93
    s_add_u32 s86, s86, 49152
    v_add3_u32 v10, v5, v7, s86
    v_add_u32 v11, s93, v11
    s_lshl_b32 s89, s4, 2
    s_add_u32 s89, s89, s81
    s_lshl_b32 s89, s89, 7
    s_add_u32 s89, s89, 12861440
    s_mov_b32 s96, s82
    s_mov_b32 s97, s82
    s_mov_b32 s33, 262144
L_sagain_35:
    s_load_dwordx16 s[48:63], s[40:41], s89 glc
    s_add_u32 s85, s89, 64
    s_load_dwordx16 s[64:79], s[40:41], s85 glc
    s_sub_u32 s33, s33, 1
    s_cbranch_scc1 L_sok_34
    s_waitcnt lgkmcnt(0)
    s_xor_b64 s[48:49], s[48:49], s[96:97]
    s_xor_b64 s[50:51], s[50:51], s[96:97]
    s_or_b64 s[48:49], s[48:49], s[50:51]
    s_xor_b64 s[52:53], s[52:53], s[96:97]
    s_or_b64 s[48:49], s[48:49], s[52:53]
    s_xor_b64 s[54:55], s[54:55], s[96:97]
    s_or_b64 s[48:49], s[48:49], s[54:55]
    s_xor_b64 s[56:57], s[56:57], s[96:97]
    s_or_b64 s[48:49], s[48:49], s[56:57]
    s_xor_b64 s[58:59], s[58:59], s[96:97]
    s_or_b64 s[48:49], s[48:49], s[58:59]
    s_xor_b64 s[60:61], s[60:61], s[96:97]
    s_or_b64 s[48:49], s[48:49], s[60:61]
    s_xor_b64 s[62:63], s[62:63], s[96:97]
    s_or_b64 s[48:49], s[48:49], s[62:63]
    s_xor_b64 s[64:65], s[64:65], s[96:97]
    s_or_b64 s[48:49], s[48:49], s[64:65]
    s_xor_b64 s[66:67], s[66:67], s[96:97]
    s_or_b64 s[48:49], s[48:49], s[66:67]
    s_xor_b64 s[68:69], s[68:69], s[96:97]
    s_or_b64 s[48:49], s[48:49], s[68:69]
    s_xor_b64 s[70:71], s[70:71], s[96:97]
    s_or_b64 s[48:49], s[48:49], s[70:71]
    s_xor_b64 s[72:73], s[72:73], s[96:97]
    s_or_b64 s[48:49], s[48:49], s[72:73]
    s_xor_b64 s[74:75], s[74:75], s[96:97]
    s_or_b64 s[48:49], s[48:49], s[74:75]
    s_xor_b64 s[76:77], s[76:77], s[96:97]
    s_or_b64 s[48:49], s[48:49], s[76:77]
    s_xor_b64 s[78:79], s[78:79], s[96:97]
    s_or_b64 s[48:49], s[48:49], s[78:79]
    s_cbranch_scc0 L_sok_34
    s_sleep 32
    s_branch L_sagain_35
L_sok_34:
    s_lshl_b32 s85, s94, 12
    v_lshlrev_b32 v4, 4, v1
    buffer_load_dwordx4 v[48:51], v4, s[40:43], s85 offen offset:0 sc1
    buffer_load_dwordx4 v[52:55], v4, s[40:43], s85 offen offset:1024 sc1
    buffer_load_dwordx4 v[56:59], v4, s[40:43], s85 offen offset:2048 sc1
    buffer_load_dwordx4 v[60:63], v4, s[40:43], s85 offen offset:3072 sc1
L_conv:
    s_lshl_b32 s88, s81, 2
    s_add_u32 s88, s88, 162960
    s_waitcnt vmcnt(0)
    v_mov_b32 v4, s88
    v_mov_b32 v5, 1
    s_mov_b64 exec, 1
    ds_add_u32 v4, v5
    s_mov_b64 exec, -1
    ds_write_b128 v14, v[48:51] offset:0
    ds_write_b128 v14, v[52:55] offset:1024
    ds_write_b128 v14, v[56:59] offset:2048
    ds_write_b128 v14, v[60:63] offset:3072
    s_waitcnt lgkmcnt(0)
    v_mov_b32 v4, 162956
    v_mov_b32 v5, 1
    s_mov_b64 exec, 1
    ds_add_u32 v4, v5
    s_mov_b64 exec, -1
    v_mov_b32 v4, 162956
L_lagain_37:
    ds_read_b32 v5, v4
    s_waitcnt lgkmcnt(0)
    v_cmp_eq_u32 vcc, 8, v5
    s_cbranch_vccnz L_lok_36
    s_sleep 1
    s_branch L_lagain_37
L_lok_36:
    s_setprio 2
    ds_read_b64 v[64:65], v10 offset:0
    ds_read_b64 v[66:67], v10 offset:8
    ds_read_b128 v[96:99], v11 offset:3584
    ds_read_b64 v[68:69], v10 offset:512
    ds_read_b64 v[70:71], v10 offset:520
    ds_read_b128 v[100:103], v11 offset:3072
    ds_read_b64 v[72:73], v10 offset:1024
    ds_read_b64 v[74:75], v10 offset:1032
    ds_read_b128 v[104:107], v11 offset:2560
    ds_read_b64 v[76:77], v10 offset:1536
    ds_read_b64 v[78:79], v10 offset:1544
    ds_read_b128 v[108:111], v11 offset:2048
    ds_read_b64 v[80:81], v10 offset:2048
    ds_read_b64 v[82:83], v10 offset:2056
    ds_read_b128 v[112:115], v11 offset:1536
    ds_read_b64 v[84:85], v10 offset:2560
    ds_read_b64 v[86:87], v10 offset:2568
    ds_read_b128 v[116:119], v11 offset:1024
    ds_read_b64 v[88:89], v10 offset:3072
    ds_read_b64 v[90:91], v10 offset:3080
    ds_read_b128 v[120:123], v11 offset:512
    ds_read_b64 v[92:93], v10 offset:3584
    ds_read_b64 v[94:95], v10 offset:3592
    ds_read_b128 v[124:127], v11 offset:0
    s_waitcnt lgkmcnt(0)
    v_mfma_f32_16x16x32_bf16 v[192:195], v[64:67], v[96:99], 0
    ds_read_b64 v[128:129], v10 offset:64
    v_mfma_f32_16x16x32_bf16 v[196:199], v[64:67], v[100:103], 0
    ds_read_b64 v[130:131], v10 offset:72
    v_mfma_f32_16x16x32_bf16 v[200:203], v[64:67], v[104:107], 0
    ds_read_b128 v[160:163], v11 offset:3648
    v_mfma_f32_16x16x32_bf16 v[204:207], v[64:67], v[108:111], 0
    ds_read_b64 v[132:133], v10 offset:576
    v_mfma_f32_16x16x32_bf16 v[208:211], v[64:67], v[112:115], 0
    ds_read_b64 v[134:135], v10 offset:584
    v_mfma_f32_16x16x32_bf16 v[212:215], v[64:67], v[116:119], 0
    ds_read_b128 v[164:167], v11 offset:3136
    v_mfma_f32_16x16x32_bf16 v[216:219], v[64:67], v[120:123], 0
    ds_read_b64 v[136:137], v10 offset:1088
    v_mfma_f32_16x16x32_bf16 v[220:223], v[64:67], v[124:127], 0
    ds_read_b64 v[138:139], v10 offset:1096
    v_mfma_f32_16x16x32_bf16 v[196:199], v[68:71], v[96:99], v[196:199]
    ds_read_b128 v[168:171], v11 offset:2624
    v_mfma_f32_16x16x32_bf16 v[200:203], v[68:71], v[100:103], v[200:203]
    ds_read_b64 v[140:141], v10 offset:1600
    v_mfma_f32_16x16x32_bf16 v[204:207], v[68:71], v[104:107], v[204:207]
    ds_read_b64 v[142:143], v10 offset:1608
    v_mfma_f32_16x16x32_bf16 v[208:211], v[68:71], v[108:111], v[208:211]
    ds_read_b128 v[172:175], v11 offset:2112
    v_mfma_f32_16x16x32_bf16 v[212:215], v[68:71], v[112:115], v[212:215]
    ds_read_b64 v[144:145], v10 offset:2112
    v_mfma_f32_16x16x32_bf16 v[216:219], v[68:71], v[116:119], v[216:219]
    ds_read_b64 v[146:147], v10 offset:2120
    v_mfma_f32_16x16x32_bf16 v[220:223], v[68:71], v[120:123], v[220:223]
    ds_read_b128 v[176:179], v11 offset:1600
    v_mfma_f32_16x16x32_bf16 v[200:203], v[72:75], v[96:99], v[200:203]
    ds_read_b64 v[148:149], v10 offset:2624
    v_mfma_f32_16x16x32_bf16 v[204:207], v[72:75], v[100:103], v[204:207]
    ds_read_b64 v[150:151], v10 offset:2632
    v_mfma_f32_16x16x32_bf16 v[208:211], v[72:75], v[104:107], v[208:211]
    ds_read_b128 v[180:183], v11 offset:1088
    v_mfma_f32_16x16x32_bf16 v[212:215], v[72:75], v[108:111], v[212:215]
    ds_read_b64 v[152:153], v10 offset:3136
    v_mfma_f32_16x16x32_bf16 v[216:219], v[72:75], v[112:115], v[216:219]
    ds_read_b64 v[154:155], v10 offset:3144
    v_mfma_f32_16x16x32_bf16 v[220:223], v[72:75], v[116:119], v[220:223]
    ds_read_b128 v[184:187], v11 offset:576
    v_mfma_f32_16x16x32_bf16 v[204:207], v[76:79], v[96:99], v[204:207]
    ds_read_b64 v[156:157], v10 offset:3648
    v_mfma_f32_16x16x32_bf16 v[208:211], v[76:79], v[100:103], v[208:211]
    ds_read_b64 v[158:159], v10 offset:3656
    v_mfma_f32_16x16x32_bf16 v[212:215], v[76:79], v[104:107], v[212:215]
    ds_read_b128 v[188:191], v11 offset:64
    v_mfma_f32_16x16x32_bf16 v[216:219], v[76:79], v[108:111], v[216:219]
    v_mfma_f32_16x16x32_bf16 v[220:223], v[76:79], v[112:115], v[220:223]
    v_mfma_f32_16x16x32_bf16 v[208:211], v[80:83], v[96:99], v[208:211]
    v_mfma_f32_16x16x32_bf16 v[212:215], v[80:83], v[100:103], v[212:215]
    v_mfma_f32_16x16x32_bf16 v[216:219], v[80:83], v[104:107], v[216:219]
    v_mfma_f32_16x16x32_bf16 v[220:223], v[80:83], v[108:111], v[220:223]
    v_mfma_f32_16x16x32_bf16 v[212:215], v[84:87], v[96:99], v[212:215]
    v_mfma_f32_16x16x32_bf16 v[216:219], v[84:87], v[100:103], v[216:219]
    v_mfma_f32_16x16x32_bf16 v[220:223], v[84:87], v[104:107], v[220:223]
    v_mfma_f32_16x16x32_bf16 v[216:219], v[88:91], v[96:99], v[216:219]
    v_mfma_f32_16x16x32_bf16 v[220:223], v[88:91], v[100:103], v[220:223]
    v_mfma_f32_16x16x32_bf16 v[220:223], v[92:95], v[96:99], v[220:223]
    s_waitcnt lgkmcnt(0)
    v_mfma_f32_16x16x32_bf16 v[192:195], v[128:131], v[160:163], v[192:195]
    ds_read_b64 v[64:65], v10 offset:128
    v_mfma_f32_16x16x32_bf16 v[196:199], v[128:131], v[164:167], v[196:199]
    ds_read_b64 v[66:67], v10 offset:136
    v_mfma_f32_16x16x32_bf16 v[200:203], v[128:131], v[168:171], v[200:203]
    ds_read_b128 v[96:99], v11 offset:3712
    v_mfma_f32_16x16x32_bf16 v[204:207], v[128:131], v[172:175], v[204:207]
    ds_read_b64 v[68:69], v10 offset:640
    v_mfma_f32_16x16x32_bf16 v[208:211], v[128:131], v[176:179], v[208:211]
    ds_read_b64 v[70:71], v10 offset:648
    v_mfma_f32_16x16x32_bf16 v[212:215], v[128:131], v[180:183], v[212:215]
    ds_read_b128 v[100:103], v11 offset:3200
    v_mfma_f32_16x16x32_bf16 v[216:219], v[128:131], v[184:187], v[216:219]
    ds_read_b64 v[72:73], v10 offset:1152
    v_mfma_f32_16x16x32_bf16 v[220:223], v[128:131], v[188:191], v[220:223]
    ds_read_b64 v[74:75], v10 offset:1160
    v_mfma_f32_16x16x32_bf16 v[196:199], v[132:135], v[160:163], v[196:199]
    ds_read_b128 v[104:107], v11 offset:2688
    v_mfma_f32_16x16x32_bf16 v[200:203], v[132:135], v[164:167], v[200:203]
    ds_read_b64 v[76:77], v10 offset:1664
    v_mfma_f32_16x16x32_bf16 v[204:207], v[132:135], v[168:171], v[204:207]
    ds_read_b64 v[78:79], v10 offset:1672
    v_mfma_f32_16x16x32_bf16 v[208:211], v[132:135], v[172:175], v[208:211]
    ds_read_b128 v[108:111], v11 offset:2176
    v_mfma_f32_16x16x32_bf16 v[212:215], v[132:135], v[176:179], v[212:215]
    ds_read_b64 v[80:81], v10 offset:2176
    v_mfma_f32_16x16x32_bf16 v[216:219], v[132:135], v[180:183], v[216:219]
    ds_read_b64 v[82:83], v10 offset:2184
    v_mfma_f32_16x16x32_bf16 v[220:223], v[132:135], v[184:187], v[220:223]
    ds_read_b128 v[112:115], v11 offset:1664
    v_mfma_f32_16x16x32_bf16 v[200:203], v[136:139], v[160:163], v[200:203]
    ds_read_b64 v[84:85], v10 offset:2688
    v_mfma_f32_16x16x32_bf16 v[204:207], v[136:139], v[164:167], v[204:207]
    ds_read_b64 v[86:87], v10 offset:2696
    v_mfma_f32_16x16x32_bf16 v[208:211], v[136:139], v[168:171], v[208:211]
    ds_read_b128 v[116:119], v11 offset:1152
    v_mfma_f32_16x16x32_bf16 v[212:215], v[136:139], v[172:175], v[212:215]
    ds_read_b64 v[88:89], v10 offset:3200
    v_mfma_f32_16x16x32_bf16 v[216:219], v[136:139], v[176:179], v[216:219]
    ds_read_b64 v[90:91], v10 offset:3208
    v_mfma_f32_16x16x32_bf16 v[220:223], v[136:139], v[180:183], v[220:223]
    ds_read_b128 v[120:123], v11 offset:640
    v_mfma_f32_16x16x32_bf16 v[204:207], v[140:143], v[160:163], v[204:207]
    ds_read_b64 v[92:93], v10 offset:3712
    v_mfma_f32_16x16x32_bf16 v[208:211], v[140:143], v[164:167], v[208:211]
    ds_read_b64 v[94:95], v10 offset:3720
    v_mfma_f32_16x16x32_bf16 v[212:215], v[140:143], v[168:171], v[212:215]
    ds_read_b128 v[124:127], v11 offset:128
    v_mfma_f32_16x16x32_bf16 v[216:219], v[140:143], v[172:175], v[216:219]
    v_mfma_f32_16x16x32_bf16 v[220:223], v[140:143], v[176:179], v[220:223]
    v_mfma_f32_16x16x32_bf16 v[208:211], v[144:147], v[160:163], v[208:211]
    v_mfma_f32_16x16x32_bf16 v[212:215], v[144:147], v[164:167], v[212:215]
    v_mfma_f32_16x16x32_bf16 v[216:219], v[144:147], v[168:171], v[216:219]
    v_mfma_f32_16x16x32_bf16 v[220:223], v[144:147], v[172:175], v[220:223]
    v_mfma_f32_16x16x32_bf16 v[212:215], v[148:151], v[160:163], v[212:215]
    v_mfma_f32_16x16x32_bf16 v[216:219], v[148:151], v[164:167], v[216:219]
    v_mfma_f32_16x16x32_bf16 v[220:223], v[148:151], v[168:171], v[220:223]
    v_mfma_f32_16x16x32_bf16 v[216:219], v[152:155], v[160:163], v[216:219]
    v_mfma_f32_16x16x32_bf16 v[220:223], v[152:155], v[164:167], v[220:223]
    v_mfma_f32_16x16x32_bf16 v[220:223], v[156:159], v[160:163], v[220:223]
    s_waitcnt lgkmcnt(0)
    v_mfma_f32_16x16x32_bf16 v[192:195], v[64:67], v[96:99], v[192:195]
    ds_read_b64 v[128:129], v10 offset:192
    v_mfma_f32_16x16x32_bf16 v[196:199], v[64:67], v[100:103], v[196:199]
    ds_read_b64 v[130:131], v10 offset:200
    v_mfma_f32_16x16x32_bf16 v[200:203], v[64:67], v[104:107], v[200:203]
    ds_read_b128 v[160:163], v11 offset:3776
    v_mfma_f32_16x16x32_bf16 v[204:207], v[64:67], v[108:111], v[204:207]
    ds_read_b64 v[132:133], v10 offset:704
    v_mfma_f32_16x16x32_bf16 v[208:211], v[64:67], v[112:115], v[208:211]
    ds_read_b64 v[134:135], v10 offset:712
    v_mfma_f32_16x16x32_bf16 v[212:215], v[64:67], v[116:119], v[212:215]
    ds_read_b128 v[164:167], v11 offset:3264
    v_mfma_f32_16x16x32_bf16 v[216:219], v[64:67], v[120:123], v[216:219]
    ds_read_b64 v[136:137], v10 offset:1216
    v_mfma_f32_16x16x32_bf16 v[220:223], v[64:67], v[124:127], v[220:223]
    ds_read_b64 v[138:139], v10 offset:1224
    v_mfma_f32_16x16x32_bf16 v[196:199], v[68:71], v[96:99], v[196:199]
    ds_read_b128 v[168:171], v11 offset:2752
    v_mfma_f32_16x16x32_bf16 v[200:203], v[68:71], v[100:103], v[200:203]
    ds_read_b64 v[140:141], v10 offset:1728
    v_mfma_f32_16x16x32_bf16 v[204:207], v[68:71], v[104:107], v[204:207]
    ds_read_b64 v[142:143], v10 offset:1736
    v_mfma_f32_16x16x32_bf16 v[208:211], v[68:71], v[108:111], v[208:211]
    ds_read_b128 v[172:175], v11 offset:2240
    v_mfma_f32_16x16x32_bf16 v[212:215], v[68:71], v[112:115], v[212:215]
    ds_read_b64 v[144:145], v10 offset:2240
    v_mfma_f32_16x16x32_bf16 v[216:219], v[68:71], v[116:119], v[216:219]
    ds_read_b64 v[146:147], v10 offset:2248
    v_mfma_f32_16x16x32_bf16 v[220:223], v[68:71], v[120:123], v[220:223]
    ds_read_b128 v[176:179], v11 offset:1728
    v_mfma_f32_16x16x32_bf16 v[200:203], v[72:75], v[96:99], v[200:203]
    ds_read_b64 v[148:149], v10 offset:2752
    v_mfma_f32_16x16x32_bf16 v[204:207], v[72:75], v[100:103], v[204:207]
    ds_read_b64 v[150:151], v10 offset:2760
    v_mfma_f32_16x16x32_bf16 v[208:211], v[72:75], v[104:107], v[208:211]
    ds_read_b128 v[180:183], v11 offset:1216
    v_mfma_f32_16x16x32_bf16 v[212:215], v[72:75], v[108:111], v[212:215]
    ds_read_b64 v[152:153], v10 offset:3264
    v_mfma_f32_16x16x32_bf16 v[216:219], v[72:75], v[112:115], v[216:219]
    ds_read_b64 v[154:155], v10 offset:3272
    v_mfma_f32_16x16x32_bf16 v[220:223], v[72:75], v[116:119], v[220:223]
    ds_read_b128 v[184:187], v11 offset:704
    v_mfma_f32_16x16x32_bf16 v[204:207], v[76:79], v[96:99], v[204:207]
    ds_read_b64 v[156:157], v10 offset:3776
    v_mfma_f32_16x16x32_bf16 v[208:211], v[76:79], v[100:103], v[208:211]
    ds_read_b64 v[158:159], v10 offset:3784
    v_mfma_f32_16x16x32_bf16 v[212:215], v[76:79], v[104:107], v[212:215]
    ds_read_b128 v[188:191], v11 offset:192
    v_mfma_f32_16x16x32_bf16 v[216:219], v[76:79], v[108:111], v[216:219]
    v_mfma_f32_16x16x32_bf16 v[220:223], v[76:79], v[112:115], v[220:223]
    v_mfma_f32_16x16x32_bf16 v[208:211], v[80:83], v[96:99], v[208:211]
    v_mfma_f32_16x16x32_bf16 v[212:215], v[80:83], v[100:103], v[212:215]
    v_mfma_f32_16x16x32_bf16 v[216:219], v[80:83], v[104:107], v[216:219]
    v_mfma_f32_16x16x32_bf16 v[220:223], v[80:83], v[108:111], v[220:223]
    v_mfma_f32_16x16x32_bf16 v[212:215], v[84:87], v[96:99], v[212:215]
    v_mfma_f32_16x16x32_bf16 v[216:219], v[84:87], v[100:103], v[216:219]
    v_mfma_f32_16x16x32_bf16 v[220:223], v[84:87], v[104:107], v[220:223]
    v_mfma_f32_16x16x32_bf16 v[216:219], v[88:91], v[96:99], v[216:219]
    v_mfma_f32_16x16x32_bf16 v[220:223], v[88:91], v[100:103], v[220:223]
    v_mfma_f32_16x16x32_bf16 v[220:223], v[92:95], v[96:99], v[220:223]
    s_waitcnt lgkmcnt(0)
    v_mfma_f32_16x16x32_bf16 v[192:195], v[128:131], v[160:163], v[192:195]
    v_mfma_f32_16x16x32_bf16 v[196:199], v[128:131], v[164:167], v[196:199]
    v_mfma_f32_16x16x32_bf16 v[200:203], v[128:131], v[168:171], v[200:203]
    v_mfma_f32_16x16x32_bf16 v[204:207], v[128:131], v[172:175], v[204:207]
    v_mfma_f32_16x16x32_bf16 v[208:211], v[128:131], v[176:179], v[208:211]
    v_mfma_f32_16x16x32_bf16 v[212:215], v[128:131], v[180:183], v[212:215]
    v_mfma_f32_16x16x32_bf16 v[216:219], v[128:131], v[184:187], v[216:219]
    v_mfma_f32_16x16x32_bf16 v[220:223], v[128:131], v[188:191], v[220:223]
    v_mfma_f32_16x16x32_bf16 v[196:199], v[132:135], v[160:163], v[196:199]
    v_mfma_f32_16x16x32_bf16 v[200:203], v[132:135], v[164:167], v[200:203]
    v_mfma_f32_16x16x32_bf16 v[204:207], v[132:135], v[168:171], v[204:207]
    v_mfma_f32_16x16x32_bf16 v[208:211], v[132:135], v[172:175], v[208:211]
    v_mfma_f32_16x16x32_bf16 v[212:215], v[132:135], v[176:179], v[212:215]
    v_mfma_f32_16x16x32_bf16 v[216:219], v[132:135], v[180:183], v[216:219]
    v_mfma_f32_16x16x32_bf16 v[220:223], v[132:135], v[184:187], v[220:223]
    v_mfma_f32_16x16x32_bf16 v[200:203], v[136:139], v[160:163], v[200:203]
    v_mfma_f32_16x16x32_bf16 v[204:207], v[136:139], v[164:167], v[204:207]
    v_mfma_f32_16x16x32_bf16 v[208:211], v[136:139], v[168:171], v[208:211]
    v_mfma_f32_16x16x32_bf16 v[212:215], v[136:139], v[172:175], v[212:215]
    v_mfma_f32_16x16x32_bf16 v[216:219], v[136:139], v[176:179], v[216:219]
    v_mfma_f32_16x16x32_bf16 v[220:223], v[136:139], v[180:183], v[220:223]
    v_mfma_f32_16x16x32_bf16 v[204:207], v[140:143], v[160:163], v[204:207]
    v_mfma_f32_16x16x32_bf16 v[208:211], v[140:143], v[164:167], v[208:211]
    v_mfma_f32_16x16x32_bf16 v[212:215], v[140:143], v[168:171], v[212:215]
    v_mfma_f32_16x16x32_bf16 v[216:219], v[140:143], v[172:175], v[216:219]
    v_mfma_f32_16x16x32_bf16 v[220:223], v[140:143], v[176:179], v[220:223]
    v_mfma_f32_16x16x32_bf16 v[208:211], v[144:147], v[160:163], v[208:211]
    v_mfma_f32_16x16x32_bf16 v[212:215], v[144:147], v[164:167], v[212:215]
    v_mfma_f32_16x16x32_bf16 v[216:219], v[144:147], v[168:171], v[216:219]
    v_mfma_f32_16x16x32_bf16 v[220:223], v[144:147], v[172:175], v[220:223]
    v_mfma_f32_16x16x32_bf16 v[212:215], v[148:151], v[160:163], v[212:215]
    v_mfma_f32_16x16x32_bf16 v[216:219], v[148:151], v[164:167], v[216:219]
    v_mfma_f32_16x16x32_bf16 v[220:223], v[148:151], v[168:171], v[220:223]
    v_mfma_f32_16x16x32_bf16 v[216:219], v[152:155], v[160:163], v[216:219]
    v_mfma_f32_16x16x32_bf16 v[220:223], v[152:155], v[164:167], v[220:223]
    v_mfma_f32_16x16x32_bf16 v[220:223], v[156:159], v[160:163], v[220:223]
    s_lshl_b32 s85, s81, 12
    s_add_u32 s85, s85, 143360
    s_cmp_eq_u32 s81, 0
    s_cselect_b32 s85, 91648, s85
    v_lshl_add_u32 v14, v1, 4, s85
    s_xor_b32 s86, s81, 1
    s_lshl_b32 s86, s86, 12
    s_add_u32 s86, s86, 143360
    s_cmp_eq_u32 s81, 1
    s_cselect_b32 s86, 91648, s86
    v_lshl_add_u32 v15, v1, 4, s86
    v_add_u32 v13, s86, v13
    s_lshr_b32 s89, s81, 1
    s_lshl_b32 s89, s89, 2
    s_add_u32 s89, s89, 162976
    s_bitcmp1_b32 s81, 0
    s_waitcnt lgkmcnt(0)
    s_cbranch_scc1 L_xch1
    ds_write_b128 v14, v[208:211] offset:0
    ds_write_b128 v14, v[212:215] offset:1024
    ds_write_b128 v14, v[216:219] offset:2048
    ds_write_b128 v14, v[220:223] offset:3072
    s_branch L_xch2
L_xch1:
    ds_write_b128 v14, v[192:195] offset:0
    ds_write_b128 v14, v[196:199] offset:1024
    ds_write_b128 v14, v[200:203] offset:2048
    ds_write_b128 v14, v[204:207] offset:3072
    s_nop 1
    v_mov_b32 v192, v208
    v_mov_b32 v193, v209
    v_mov_b32 v194, v210
    v_mov_b32 v195, v211
    v_mov_b32 v196, v212
    v_mov_b32 v197, v213
    v_mov_b32 v198, v214
    v_mov_b32 v199, v215
    v_mov_b32 v200, v216
    v_mov_b32 v201, v217
    v_mov_b32 v202, v218
    v_mov_b32 v203, v219
    v_mov_b32 v204, v220
    v_mov_b32 v205, v221
    v_mov_b32 v206, v222
    v_mov_b32 v207, v223
L_xch2:
    ds_read_b64 v[64:65], v12 offset:1536
    ds_read_b64 v[66:67], v12 offset:1024
    ds_read_b64 v[68:69], v12 offset:512
    ds_read_b64 v[70:71], v12 offset:0
    s_bitcmp1_b32 s94, 0
    s_cselect_b32 s88, 0, 16
    s_lshl_b32 s88, s84, s88
    s_and_b32 s88, s88, 0xffff0000
    s_waitcnt lgkmcnt(0)
    v_mov_b32 v4, s89
    v_mov_b32 v5, 1
    s_mov_b64 exec, 1
    ds_add_u32 v4, v5
    s_mov_b64 exec, -1
    v_and_b32 v72, 0xffff0000, v65
    v_lshlrev_b32 v73, 16, v65
    v_and_b32 v74, 0xffff0000, v64
    v_lshlrev_b32 v75, 16, v64
    v_fmac_f32 v192, s88, v72
    v_fmac_f32 v193, s88, v73
    v_fmac_f32 v194, s88, v74
    v_fmac_f32 v195, s88, v75
    v_and_b32 v76, 0xffff0000, v67
    v_lshlrev_b32 v77, 16, v67
    v_and_b32 v78, 0xffff0000, v66
    v_lshlrev_b32 v79, 16, v66
    v_fmac_f32 v196, s88, v76
    v_fmac_f32 v197, s88, v77
    v_fmac_f32 v198, s88, v78
    v_fmac_f32 v199, s88, v79
    v_and_b32 v80, 0xffff0000, v69
    v_lshlrev_b32 v81, 16, v69
    v_and_b32 v82, 0xffff0000, v68
    v_lshlrev_b32 v83, 16, v68
    v_fmac_f32 v200, s88, v80
    v_fmac_f32 v201, s88, v81
    v_fmac_f32 v202, s88, v82
    v_fmac_f32 v203, s88, v83
    v_and_b32 v84, 0xffff0000, v71
    v_lshlrev_b32 v85, 16, v71
    v_and_b32 v86, 0xffff0000, v70
    v_lshlrev_b32 v87, 16, v70
    v_fmac_f32 v204, s88, v84
    v_fmac_f32 v205, s88, v85
    v_fmac_f32 v206, s88, v86
    v_fmac_f32 v207, s88, v87
    v_mov_b32 v4, s89
L_lagain_39:
    ds_read_b32 v5, v4
    s_waitcnt lgkmcnt(0)
    v_cmp_eq_u32 vcc, 2, v5
    s_cbranch_vccnz L_lok_38
    s_sleep 1
    s_branch L_lagain_39
L_lok_38:
    ds_read_b128 v[72:75], v15 offset:0
    ds_read_b128 v[76:79], v15 offset:1024
    ds_read_b128 v[80:83], v15 offset:2048
    ds_read_b128 v[84:87], v15 offset:3072
    s_and_b32 s86, s81, 1
    s_lshl_b32 s86, s86, 11
    s_lshl_b32 s85, s94, 12
    s_add_u32 s85, s85, s86
    s_add_u32 s85, s85, 2097152
    v_lshlrev_b32 v5, 4, v1
    s_waitcnt lgkmcnt(0)
    v_add_f32 v192, v192, v72
    v_add_f32 v193, v193, v73
    v_add_f32 v194, v194, v74
    v_add_f32 v195, v195, v75
    v_cvt_pk_bf16_f32 v64, v192, v193
    v_cvt_pk_bf16_f32 v65, v194, v195
    ds_write_b64 v13, v[64:65] offset:0
    v_add_f32 v196, v196, v76
    v_add_f32 v197, v197, v77
    v_add_f32 v198, v198, v78
    v_add_f32 v199, v199, v79
    v_cvt_pk_bf16_f32 v66, v196, v197
    v_cvt_pk_bf16_f32 v67, v198, v199
    ds_write_b64 v13, v[66:67] offset:512
    v_add_f32 v200, v200, v80
    v_add_f32 v201, v201, v81
    v_add_f32 v202, v202, v82
    v_add_f32 v203, v203, v83
    v_cvt_pk_bf16_f32 v68, v200, v201
    v_cvt_pk_bf16_f32 v69, v202, v203
    ds_write_b64 v13, v[68:69] offset:1024
    v_add_f32 v204, v204, v84
    v_add_f32 v205, v205, v85
    v_add_f32 v206, v206, v86
    v_add_f32 v207, v207, v87
    v_cvt_pk_bf16_f32 v70, v204, v205
    v_cvt_pk_bf16_f32 v71, v206, v207
    ds_write_b64 v13, v[70:71] offset:1536
    s_waitcnt lgkmcnt(0)
    ds_read_b128 v[72:75], v15
    ds_read_b128 v[76:79], v15 offset:1024
    s_waitcnt lgkmcnt(0)
    buffer_store_dwordx4 v[72:75], v5, s[40:43], s85 offen sc1
    buffer_store_dwordx4 v[76:79], v5, s[40:43], s85 offen offset:1024 sc1
    s_setprio 0
    s_lshl_b32 s85, s4, 10
    s_lshl_b32 s87, s5, 2
    s_add_u32 s85, s85, s87
    s_add_u32 s85, s85, 12943360
    v_lshlrev_b32 v101, 7, v1
    v_mov_b32 v100, s82
    v_mov_b32 v102, 162952
    v_mov_b32 v103, 1
    s_waitcnt vmcnt(0)
    s_mov_b64 exec, 1
    ds_add_rtn_u32 v103, v102, v103
    s_waitcnt lgkmcnt(0)
    v_readfirstlane_b32 s87, v103
    s_mov_b64 exec, 0xff
    s_cmp_lg_u32 s87, 3
    s_cbranch_scc1 L_ynopub
    buffer_store_dword v100, v101, s[40:43], s85 offen sc1
L_ynopub:
    s_mov_b64 exec, -1
    v_lshrrev_b32 v5, 3, v0
    s_lshl_b32 s88, s80, 6
    v_add_u32 v5, s88, v5
    v_lshlrev_b32 v5, 10, v5
    v_and_b32 v9, 7, v0
    v_lshl_add_u32 v9, v9, 4, v5
    s_lshl_b32 s88, s7, 7
    v_add_u32 v9, s88, v9
    buffer_load_dwordx4 v[96:99], v9, s[36:39], 0 offen
    s_lshl_b32 s89, s7, 3
    s_add_u32 s89, s89, s4
    s_lshl_b32 s89, s89, 7
    s_add_u32 s89, s89, 12943360
    v_lshrrev_b32 v4, 3, v1
    v_lshlrev_b32 v4, 12, v4
    v_and_b32 v5, 7, v1
    v_lshl_add_u32 v4, v5, 4, v4
    s_lshl_b32 s87, s7, 18
    s_lshl_b32 s88, s81, 16
    s_add_u32 s87, s87, s88
    s_lshl_b32 s88, s80, 7
    s_add_u32 s87, s87, s88
    s_add_u32 s87, s87, 2097152
    s_add_u32 s88, s87, 32768
    s_cmp_lg_u32 s81, 0
    s_cbranch_scc1 L_ywait
    s_mov_b32 s33, 262144
L_sagain_41:
    s_load_dwordx16 s[48:63], s[40:41], s89 glc
    s_add_u32 s85, s89, 64
    s_load_dwordx16 s[64:79], s[40:41], s85 glc
    s_sub_u32 s33, s33, 1
    s_cbranch_scc1 L_sok_40
    s_waitcnt lgkmcnt(0)
    s_xor_b64 s[48:49], s[48:49], s[96:97]
    s_xor_b64 s[50:51], s[50:51], s[96:97]
    s_or_b64 s[48:49], s[48:49], s[50:51]
    s_xor_b64 s[52:53], s[52:53], s[96:97]
    s_or_b64 s[48:49], s[48:49], s[52:53]
    s_xor_b64 s[54:55], s[54:55], s[96:97]
    s_or_b64 s[48:49], s[48:49], s[54:55]
    s_xor_b64 s[56:57], s[56:57], s[96:97]
    s_or_b64 s[48:49], s[48:49], s[56:57]
    s_xor_b64 s[58:59], s[58:59], s[96:97]
    s_or_b64 s[48:49], s[48:49], s[58:59]
    s_xor_b64 s[60:61], s[60:61], s[96:97]
    s_or_b64 s[48:49], s[48:49], s[60:61]
    s_xor_b64 s[62:63], s[62:63], s[96:97]
    s_or_b64 s[48:49], s[48:49], s[62:63]
    s_xor_b64 s[64:65], s[64:65], s[96:97]
    s_or_b64 s[48:49], s[48:49], s[64:65]
    s_xor_b64 s[66:67], s[66:67], s[96:97]
    s_or_b64 s[48:49], s[48:49], s[66:67]
    s_xor_b64 s[68:69], s[68:69], s[96:97]
    s_or_b64 s[48:49], s[48:49], s[68:69]
    s_xor_b64 s[70:71], s[70:71], s[96:97]
    s_or_b64 s[48:49], s[48:49], s[70:71]
    s_xor_b64 s[72:73], s[72:73], s[96:97]
    s_or_b64 s[48:49], s[48:49], s[72:73]
    s_xor_b64 s[74:75], s[74:75], s[96:97]
    s_or_b64 s[48:49], s[48:49], s[74:75]
    s_xor_b64 s[76:77], s[76:77], s[96:97]
    s_or_b64 s[48:49], s[48:49], s[76:77]
    s_xor_b64 s[78:79], s[78:79], s[96:97]
    s_or_b64 s[48:49], s[48:49], s[78:79]
    s_cbranch_scc0 L_sok_40
    s_sleep 8
    s_branch L_sagain_41
L_sok_40:
    v_mov_b32 v6, 162952
L_lagain_43:
    ds_read_b32 v7, v6
    s_waitcnt lgkmcnt(0)
    v_cmp_eq_u32 vcc, 4, v7
    s_cbranch_vccnz L_lok_42
    s_sleep 1
    s_branch L_lagain_43
L_lok_42:
    v_mov_b32 v6, 162984
    v_mov_b32 v7, 1
    s_mov_b64 exec, 1
    ds_add_u32 v6, v7
    s_mov_b64 exec, -1
L_ywait:
    v_mov_b32 v6, 162984
L_lagain_45:
    ds_read_b32 v7, v6
    s_waitcnt lgkmcnt(0)
    v_cmp_eq_u32 vcc, 1, v7
    s_cbranch_vccnz L_lok_44
    s_sleep 1
    s_branch L_lagain_45
L_lok_44:
    buffer_load_dwordx4 v[40:43], v4, s[40:43], s87 offen sc1
    buffer_load_dwordx4 v[44:47], v4, s[40:43], s88 offen sc1
    v_bfe_u32 v4, v1, 2, 2
    v_lshlrev_b32 v4, 7, v4
    v_lshrrev_b32 v5, 4, v1
    v_lshl_add_u32 v4, v5, 5, v4
    v_and_b32 v5, 3, v1
    v_lshl_add_u32 v4, v5, 3, v4
    s_lshl_b32 s85, s81, 11
    s_add_u32 s85, s85, 49152
    v_add_u32 v4, s85, v4
    v_mul_u32_u24 v5, 144, v1
    s_lshl_b32 s85, s81, 5
    s_add_u32 s85, s85, 57344
    v_add_u32 v5, s85, v5
    s_lshl_b32 s85, s81, 11
    s_add_u32 s85, s85, 49152
    v_lshl_add_u32 v14, v1, 4, s85
    s_waitcnt vmcnt(0)
    ds_write_b128 v14, v[40:43]
    ds_write_b128 v14, v[44:47] offset:1024
    s_waitcnt lgkmcnt(0)
    ds_read_b64_tr_b16 v[48:49], v4 offset:0
    ds_read_b64_tr_b16 v[50:51], v4 offset:512
    ds_read_b64_tr_b16 v[52:53], v4 offset:1024
    ds_read_b64_tr_b16 v[54:55], v4 offset:1536
    s_waitcnt lgkmcnt(0)
    ds_write_b128 v5, v[48:51]
    ds_write_b128 v5, v[52:55] offset:16
L_final:
    v_lshrrev_b32 v4, 3, v0
    v_and_b32 v5, 7, v0
    v_and_b32 v6, 31, v4
    v_mul_u32_u24 v6, 272, v6
    v_lshl_add_u32 v6, v5, 5, v6
    v_lshrrev_b32 v7, 5, v4
    v_mul_u32_u24 v7, 98304, v7
    v_add_u32 v6, v6, v7
    v_mul_u32_u24 v7, 144, v4
    v_lshl_add_u32 v7, v5, 4, v7
    v_add_u32 v7, 57344, v7
    s_lshl_b32 s85, s34, 9
    s_add_u32 s85, s85, 160896
    v_lshl_add_u32 v8, v4, 3, s85
    ds_read_b64 v[52:53], v8
    v_lshlrev_b32 v56, 16, v96
    v_and_b32 v57, 0xffff0000, v96
    v_lshlrev_b32 v58, 16, v97
    v_and_b32 v59, 0xffff0000, v97
    v_lshlrev_b32 v60, 16, v98
    v_and_b32 v61, 0xffff0000, v98
    v_lshlrev_b32 v62, 16, v99
    v_and_b32 v63, 0xffff0000, v99
    s_waitcnt lgkmcnt(0)
    v_mul_f32 v54, 0xbf317218, v53
    v_mov_b32 v90, v53
    v_mul_f32 v88, v52, v54
    s_barrier
    ds_read_b128 v[48:51], v7
    ds_read_b128 v[16:19], v6 offset:0
    ds_read_b128 v[20:23], v6 offset:16
    ds_read_b128 v[24:27], v6 offset:12288
    ds_read_b128 v[28:31], v6 offset:12304
    ds_read_b128 v[32:35], v6 offset:24576
    ds_read_b128 v[36:39], v6 offset:24592
    ds_read_b128 v[40:43], v6 offset:36864
    ds_read_b128 v[44:47], v6 offset:36880
    v_pk_fma_f32 v[80:81], v[56:57], v[54:55], v[88:89] op_sel_hi:[1,0,0] neg_lo:[0,0,1] neg_hi:[0,0,1]
    v_pk_fma_f32 v[82:83], v[58:59], v[54:55], v[88:89] op_sel_hi:[1,0,0] neg_lo:[0,0,1] neg_hi:[0,0,1]
    v_pk_fma_f32 v[84:85], v[60:61], v[54:55], v[88:89] op_sel_hi:[1,0,0] neg_lo:[0,0,1] neg_hi:[0,0,1]
    v_pk_fma_f32 v[86:87], v[62:63], v[54:55], v[88:89] op_sel_hi:[1,0,0] neg_lo:[0,0,1] neg_hi:[0,0,1]
    s_waitcnt lgkmcnt(8)
    v_lshlrev_b32 v72, 16, v48
    v_and_b32 v73, 0xffff0000, v48
    v_lshlrev_b32 v74, 16, v49
    v_and_b32 v75, 0xffff0000, v49
    v_lshlrev_b32 v76, 16, v50
    v_and_b32 v77, 0xffff0000, v50
    v_lshlrev_b32 v78, 16, v51
    v_and_b32 v79, 0xffff0000, v51
    v_pk_mul_f32 v[80:81], v[80:81], v[72:73]
    v_pk_mul_f32 v[82:83], v[82:83], v[74:75]
    v_pk_mul_f32 v[84:85], v[84:85], v[76:77]
    v_pk_mul_f32 v[86:87], v[86:87], v[78:79]
    s_waitcnt lgkmcnt(4)
    v_pk_add_f32 v[16:17], v[16:17], v[24:25]
    v_pk_add_f32 v[18:19], v[18:19], v[26:27]
    v_pk_add_f32 v[20:21], v[20:21], v[28:29]
    v_pk_add_f32 v[22:23], v[22:23], v[30:31]
    s_waitcnt lgkmcnt(0)
    v_pk_add_f32 v[32:33], v[32:33], v[40:41]
    v_pk_add_f32 v[34:35], v[34:35], v[42:43]
    v_pk_add_f32 v[36:37], v[36:37], v[44:45]
    v_pk_add_f32 v[38:39], v[38:39], v[46:47]
    v_pk_add_f32 v[16:17], v[16:17], v[32:33]
    v_pk_add_f32 v[18:19], v[18:19], v[34:35]
    v_pk_add_f32 v[20:21], v[20:21], v[36:37]
    v_pk_add_f32 v[22:23], v[22:23], v[38:39]
    v_pk_mul_f32 v[16:17], v[16:17], v[90:91] op_sel_hi:[1,0]
    v_pk_mul_f32 v[18:19], v[18:19], v[90:91] op_sel_hi:[1,0]
    v_pk_mul_f32 v[20:21], v[20:21], v[90:91] op_sel_hi:[1,0]
    v_pk_mul_f32 v[22:23], v[22:23], v[90:91] op_sel_hi:[1,0]
    v_exp_f32 v24, v16
    v_exp_f32 v25, v17
    v_pk_mul_f32 v[80:81], v[80:81], v[16:17]
    v_exp_f32 v26, v18
    v_exp_f32 v27, v19
    v_pk_mul_f32 v[82:83], v[82:83], v[18:19]
    v_exp_f32 v28, v20
    v_exp_f32 v29, v21
    v_pk_mul_f32 v[84:85], v[84:85], v[20:21]
    v_exp_f32 v30, v22
    v_exp_f32 v31, v23
    v_pk_mul_f32 v[86:87], v[86:87], v[22:23]
    v_pk_add_f32 v[24:25], v[24:25], 1.0 op_sel_hi:[1,0]
    v_pk_add_f32 v[26:27], v[26:27], 1.0 op_sel_hi:[1,0]
    v_pk_add_f32 v[28:29], v[28:29], 1.0 op_sel_hi:[1,0]
    v_pk_add_f32 v[30:31], v[30:31], 1.0 op_sel_hi:[1,0]
    v_rcp_f32 v24, v24
    v_rcp_f32 v25, v25
    v_rcp_f32 v26, v26
    v_rcp_f32 v27, v27
    v_rcp_f32 v28, v28
    v_rcp_f32 v29, v29
    v_rcp_f32 v30, v30
    v_rcp_f32 v31, v31
    v_pk_fma_f32 v[56:57], v[80:81], v[24:25], v[56:57]
    v_pk_fma_f32 v[58:59], v[82:83], v[26:27], v[58:59]
    v_pk_fma_f32 v[60:61], v[84:85], v[28:29], v[60:61]
    v_pk_fma_f32 v[62:63], v[86:87], v[30:31], v[62:63]
    v_cvt_pk_bf16_f32 v48, v56, v57
    v_cvt_pk_bf16_f32 v49, v58, v59
    v_cvt_pk_bf16_f32 v50, v60, v61
    v_cvt_pk_bf16_f32 v51, v62, v63
    buffer_store_dwordx4 v[48:51], v9, s[44:47], 0 offen sc1
L_end:
    s_endpgm
L_code_end:
.section .rodata,"a"
.p2align 6
.amdhsa_kernel recurrent_scan__ssm_conv_h3__glu_gated_swiglu__prompt_kernel
  .amdhsa_next_free_vgpr 256
  .amdhsa_next_free_sgpr 102
  .amdhsa_accum_offset 256
  .amdhsa_group_segment_fixed_size 0
  .amdhsa_kernarg_size 104
  .amdhsa_user_sgpr_count 2
  .amdhsa_user_sgpr_kernarg_segment_ptr 1
  .amdhsa_system_sgpr_workgroup_id_x 1
  .amdhsa_float_denorm_mode_32 3
.end_amdhsa_kernel
```
